```python
import torch

def _softmax(x, axis=-1):
    return torch.softmax(x, dim=axis)

def _gelu(x):
    return torch.nn.functional.gelu(x, approximate='tanh')

def _silu(x):
    return torch.nn.functional.silu(x)

def _sigmoid(x):
    return torch.sigmoid(x)

def _layernorm(x, axis=-1, eps=1e-05):
    m = x.mean(dim=axis, keepdim=True)
    v = x.var(dim=axis, keepdim=True, unbiased=False)
    return (x - m) / torch.sqrt(v + eps)

def _scatter_add(tgt, idx, src, axis=0):
    return tgt.clone().index_add_(axis, idx, src)

def _segment_sum(src, seg, n):
    out = torch.zeros((n,) + src.shape[1:], dtype=src.dtype)
    return out.index_add_(0, seg, src)

def _pad(x, pw):
    flat = tuple((v for pair in reversed(pw) for v in pair))
    return torch.nn.functional.pad(x, flat)
kernel_name = 'adaLN_cond__gqa_block_cached__swiglu_ffn__decode'

def setup_inputs():

    _w = lambda a: (lambda t: t.to(torch.bfloat16) if t.is_floating_point() else t)(torch.as_tensor(a))

    def _A_setup():
        B, Sq, D = (2, 1, 640)
        Hq, Hkv, Sk, Dh = (32, 32, 8192, 192)
        assert Hq % Hkv == 0, (Hq, Hkv)
        return {'x': _w((lambda *s: torch.randn(*s, dtype=torch.bfloat16) * 0.05)(B, Sq, D)), 'k_cache': _w((lambda *s: torch.randn(*s, dtype=torch.bfloat16) * 0.8)(B, Hkv, Sk, Dh)), 'v_cache': _w((lambda *s: torch.randn(*s, dtype=torch.bfloat16) * 1.6)(B, Hkv, Sk, Dh)), 'wq': _w((lambda *s: torch.randn(*s, dtype=torch.bfloat16) * 0.8)(D, Hq * Dh) * D ** (-0.5)), 'wo': _w((lambda *s: torch.randn(*s, dtype=torch.bfloat16) * 1.6)(Hq * Dh, D) * (Hq * Dh) ** (-0.5))}
    _A_in = _A_setup()

    def _B_setup():
        B, S, D, F = (2, 1, 640, 1536)
        return {'x': _w((lambda *s: torch.randn(*s, dtype=torch.bfloat16) * 0.05)(B, S, D)), 'w_gate': _w((lambda *s: torch.randn(*s, dtype=torch.bfloat16) * 0.1)(D, F)), 'w_up': _w((lambda *s: torch.randn(*s, dtype=torch.bfloat16) * 0.1)(D, F)), 'w_down': _w((lambda *s: torch.randn(*s, dtype=torch.bfloat16) * 0.1)(F, D))}
    _B_in = _B_setup()
    return {'A_x': _A_in['x'], 'A_k_cache': _A_in['k_cache'], 'A_v_cache': _A_in['v_cache'], 'A_wq': _A_in['wq'], 'A_wo': _A_in['wo'], 'B_x': _B_in['x'], 'B_w_gate': _B_in['w_gate'], 'B_w_up': _B_in['w_up'], 'B_w_down': _B_in['w_down'], 'c': _w((lambda *s: torch.randn(*s, dtype=torch.bfloat16) * 0.4)(2, 640) * 8.0), 'w_mod': _w((lambda *s: torch.randn(*s, dtype=torch.bfloat16) * 0.4)(640, 6 * 640) * 640 ** (-0.5) * 8.0)}

def reference(A_x, A_k_cache, A_v_cache, A_wq, A_wo, B_x, B_w_gate, B_w_up, B_w_down, c, w_mod):

    def _A_ref(x, k_cache, v_cache, wq, wo):
        B, Sq, D = x.shape
        Hq, Dh = (32, 192)
        Hkv = k_cache.shape[1]
        rep = Hq // Hkv
        q = (lambda x, *d: x.permute(*d))((x @ wq).reshape(B, Sq, Hq, Dh), 0, 2, 1, 3)
        k = (lambda x, n, axis: torch.repeat_interleave(x, n, dim=axis))(k_cache, rep, axis=1)
        v = (lambda x, n, axis: torch.repeat_interleave(x, n, dim=axis))(v_cache, rep, axis=1)
        scores = torch.einsum('bhqd,bhkd->bhqk', q, k) * Dh ** (-0.5)
        p = _softmax(scores, axis=-1)
        o = torch.einsum('bhqk,bhkd->bhqd', p, v)
        return (lambda x, *d: x.permute(*d))(o, 0, 2, 1, 3).reshape(B, Sq, Hq * Dh) @ wo

    def _B_ref(x, w_gate, w_up, w_down):
        g = _silu(x @ w_gate)
        u = x @ w_up
        return g * u @ w_down
    x = A_x
    mod = (_silu(c) @ w_mod).reshape(c.shape[0], 6, 1, -1)
    sa, ca, ga, sb, cb, gb = (mod[:, 0].clone(), mod[:, 1].clone(), mod[:, 2].clone(), mod[:, 3].clone(), mod[:, 4].clone(), mod[:, 5].clone())
    h = _layernorm(x, axis=-1) * (1 + ca) + sa
    x = x + ga * _A_ref(h, A_k_cache, A_v_cache, A_wq, A_wo)
    h = _layernorm(x, axis=-1) * (1 + cb) + sb
    x = x + gb * _B_ref(h, B_w_gate, B_w_up, B_w_down)
    return x
```

```asm
; @launch grid=(256,1,1) block=(512,1,1) lds=154240
.amdgcn_target "amdgcn-amd-amdhsa--gfx950"
.text
.globl adaLN_cond__gqa_block_cached__swiglu_ffn__decode_kernel
.p2align 8
.type adaLN_cond__gqa_block_cached__swiglu_ffn__decode_kernel,@function
adaLN_cond__gqa_block_cached__swiglu_ffn__decode_kernel:
  s_cmp_ge_u32 s2, 256
  s_cbranch_scc1 L_end
  s_load_dwordx16 s[64:79], s[0:1], 0
  v_lshrrev_b32 v1, 6, v0
  s_load_dwordx8 s[80:87], s[0:1], 64
  v_readfirstlane_b32 s3, v1
  s_load_dwordx4 s[88:91], s[0:1], 96
  v_and_b32 v0, 63, v0
  s_cmp_ge_u32 s3, 4
  s_cbranch_scc1 L_helper
  s_and_b32 s13, s2, 7
  s_lshr_b32 s14, s2, 4
  s_lshl4_add_u32 s34, s13, s14
  s_mul_i32 s34, s34, 196608
  s_bfe_u32 s12, s2, 0x10003
  s_lshl2_add_u32 s12, s12, s3
  s_mul_i32 s36, s12, 392
  s_lshr_b32 s36, s36, 10
  s_mul_i32 s36, s36, 22
  s_lshl3_add_u32 s36, s12, s36
  s_mul_i32 s36, s36, 1536
  v_and_b32 v1, 1, v0
  v_lshrrev_b32 v2, 4, v0
  v_lshl_add_u32 v1, v1, 2, v2
  v_lshlrev_b32 v51, 4, v1
  v_bfe_u32 v1, v0, 1, 2
  v_bfe_u32 v2, v0, 3, 1
  v_mul_u32_u24 v2, 84, v2
  v_add_u32 v1, v1, v2
  v_mul_u32_u24 v1, 384, v1
  v_add_u32 v40, v1, v51
  s_mov_b32 s10, 196608
  s_mov_b32 s11, 0x20000
  s_waitcnt lgkmcnt(0)
  s_add_u32 s8, s66, s34
  s_addc_u32 s9, s67, 0
  buffer_load_dwordx4 v[64:67], v40, s[8:11], s36 offen offset:0 nt
  buffer_load_dwordx4 v[68:71], v40, s[8:11], s36 offen offset:128 nt
  buffer_load_dwordx4 v[72:75], v40, s[8:11], s36 offen offset:256 nt
  buffer_load_dwordx4 v[76:79], v40, s[8:11], s36 offen offset:1536 nt
  s_barrier
  s_branch L_stream
L_helper:
  s_getpc_b64 s[92:93]
L_pc:
  s_lshr_b32 s8, s2, 3
  s_lshl2_add_u32 s8, s8, s3
  s_lshl_b32 s8, s8, 6
  s_load_dword s9, s[92:93], s8
  s_add_u32 s8, s8, 8192
  s_min_u32 s8, s8, L_tab-L_pc
  s_load_dword s9, s[92:93], s8
  s_add_u32 s8, s8, 8192
  s_min_u32 s8, s8, L_tab-L_pc
  s_load_dword s9, s[92:93], s8
  s_add_u32 s8, s8, 8192
  s_min_u32 s8, s8, L_tab-L_pc
  s_load_dword s9, s[92:93], s8
  s_add_u32 s8, s8, 8192
  s_min_u32 s8, s8, L_tab-L_pc
  s_load_dword s9, s[92:93], s8
  s_add_u32 s92, s92, L_tab-L_pc
  s_addc_u32 s93, s93, 0
  s_lshl_b32 s8, s2, 2
  s_load_dword s36, s[92:93], s8
  s_setprio 3
  s_sub_u32 s38, s3, 4
  s_mul_i32 s37, s38, 24576
  s_mov_b32 s39, 147456
  v_mov_b32 v1, 153728
  v_mov_b32 v2, 0
  v_mov_b32 v3, 0
  ds_write_b64 v1, v[2:3]
  ds_write_b64 v1, v[2:3] offset:8
  ds_write_b64 v1, v[2:3] offset:16
  ds_write_b64 v1, v[2:3] offset:24
  ds_write_b64 v1, v[2:3] offset:32
  ds_write_b64 v1, v[2:3] offset:40
  v_lshrrev_b32 v18, 3, v0
  v_lshrrev_b32 v20, 4, v0
  v_and_b32 v1, 1, v20
  v_lshlrev_b32 v1, 1, v1
  v_and_b32 v2, 7, v0
  v_xor_b32 v19, v1, v2
  v_and_b32 v22, 1, v0
  v_bfe_u32 v1, v0, 1, 3
  v_min_u32 v1, 4, v1
  v_lshlrev_b32 v1, 5, v1
  v_lshl_add_u32 v21, v20, 3, v1
  s_mul_i32 s41, s38, 160
  v_add_u32 v23, s41, v21
  s_mov_b32 s16, 0x03ff03ff
  s_mov_b32 s17, 0x03ff03ff
  s_waitcnt lgkmcnt(0)
  s_mov_b32 s4, s90
  s_mov_b32 s5, s91
  s_mov_b32 s6, 999424
  s_mov_b32 s7, 0x20000
  s_bitcmp1_b32 s36, 28
  s_cbranch_scc1 L_clear
L_job:
  s_and_b32 s10, s36, 15
  s_bfe_u32 s40, s36, 0x80004
  s_lshr_b32 s36, s36, 12
  s_and_b32 s36, s36, 0xfff
  s_cmp_eq_u32 s10, 1
  s_cbranch_scc1 L_M
  s_cmp_eq_u32 s10, 2
  s_cbranch_scc1 L_Q
  s_cmp_eq_u32 s10, 3
  s_cbranch_scc1 L_W
  s_cmp_eq_u32 s10, 4
  s_cbranch_scc1 L_F
  s_cmp_eq_u32 s10, 5
  s_cbranch_scc1 L_D
  s_branch L_idle
L_next:
  s_cmp_eq_u32 s36, 0
  s_cbranch_scc1 L_idle
  v_mov_b32 v1, 153728
  s_mov_b32 s9, 2097152
L1_lw:
  ds_read_b32 v2, v1 offset:4
  s_waitcnt lgkmcnt(0)
  v_readfirstlane_b32 s8, v2
  s_nop 0
  s_cmp_ge_u32 s8, 5
  s_cbranch_scc1 L2_lwd
  s_sleep 2
  s_sub_u32 s9, s9, 1
  s_cbranch_scc0 L1_lw
L2_lwd:
  s_add_u32 s39, s39, 2048
  s_branch L_job
L_clear:
  s_bfe_u32 s10, s36, 0x40018
  s_lshl2_add_u32 s10, s10, s38
  v_mov_b32 v4, -1
  v_mov_b32 v5, -1
  v_mov_b32 v6, -1
  v_mov_b32 v7, -1
  s_mov_b32 s11, 4096
  s_cmp_ge_u32 s10, 8
  s_cbranch_scc1 L_clrB
  s_mul_i32 s12, s10, 5120
  v_lshl_add_u32 v1, v0, 4, s12
  buffer_store_dwordx4 v[4:7], v1, s[4:7], 0 offen offset:0 sc1
  buffer_store_dwordx4 v[4:7], v1, s[4:7], 0 offen offset:1024 sc1
  buffer_store_dwordx4 v[4:7], v1, s[4:7], 0 offen offset:2048 sc1
  buffer_store_dwordx4 v[4:7], v1, s[4:7], 0 offen offset:3072 sc1
  buffer_store_dwordx4 v[4:7], v1, s[4:7], s11 offen offset:0 sc1
  s_branch L_clrF
L_clrB:
  s_add_u32 s12, s10, 32
  s_lshl_b32 s12, s12, 10
  v_lshl_add_u32 v1, v0, 4, s12
  s_mov_b32 s6, 409600
  buffer_store_dwordx4 v[4:7], v1, s[4:7], 0 offen sc1
  v_add_u32 v1, 32768, v1
  buffer_store_dwordx4 v[4:7], v1, s[4:7], 0 offen sc1
  v_add_u32 v1, 32768, v1
  s_sub_u32 s12, s10, 8
  s_bitcmp1_b32 1057425407, s12
  s_cbranch_scc0 L3_nc
  buffer_store_dwordx4 v[4:7], v1, s[4:7], 0 offen sc1
L3_nc:
  v_add_u32 v1, 32768, v1
  s_sub_u32 s12, s10, 8
  s_bitcmp1_b32 522133311, s12
  s_cbranch_scc0 L4_nc
  buffer_store_dwordx4 v[4:7], v1, s[4:7], 0 offen sc1
L4_nc:
  v_add_u32 v1, 32768, v1
  s_sub_u32 s12, s10, 8
  s_bitcmp1_b32 522133279, s12
  s_cbranch_scc0 L5_nc
  buffer_store_dwordx4 v[4:7], v1, s[4:7], 0 offen sc1
L5_nc:
  v_add_u32 v1, 32768, v1
  s_sub_u32 s12, s10, 8
  s_bitcmp1_b32 4294967071, s12
  s_cbranch_scc0 L6_nc
  buffer_store_dwordx4 v[4:7], v1, s[4:7], 0 offen sc1
L6_nc:
  v_add_u32 v1, 32768, v1
  buffer_store_dwordx4 v[4:7], v1, s[4:7], 0 offen sc1
  v_add_u32 v1, 32768, v1
  buffer_store_dwordx4 v[4:7], v1, s[4:7], 0 offen sc1
  v_add_u32 v1, 32768, v1
  buffer_store_dwordx4 v[4:7], v1, s[4:7], 0 offen sc1
  v_add_u32 v1, 32768, v1
  buffer_store_dwordx4 v[4:7], v1, s[4:7], 0 offen sc1
  v_add_u32 v1, 32768, v1
  buffer_store_dwordx4 v[4:7], v1, s[4:7], 0 offen sc1
  v_add_u32 v1, 32768, v1
  buffer_store_dwordx4 v[4:7], v1, s[4:7], 0 offen sc1
  v_add_u32 v1, 32768, v1
  s_add_u32 s10, s10, 24
  s_mov_b32 s6, 999424
L_clrF:
  s_lshl_b32 s10, s10, 2
  v_mov_b32 v1, s10
  s_waitcnt vmcnt(0)
  s_mov_b64 exec, 1
  global_store_dword v1, v4, s[88:89] sc1
  s_mov_b64 exec, -1
  s_branch L_job
L_M:
  v_mul_u32_u24 v1, 640, v22
  v_add_lshl_u32 v1, v1, v23, 1
  global_load_dwordx4 v[28:31], v1, s[82:83]
  s_lshl_b32 s12, s40, 7
  s_mul_i32 s10, s41, 7680
  s_add_u32 s10, s10, s12
  s_add_u32 s10, s84, s10
  s_addc_u32 s11, s85, 0
  v_mul_u32_u24 v1, 7680, v18
  v_lshl_add_u32 v10, v19, 4, v1
  v_xor_b32 v2, 4, v19
  v_lshl_add_u32 v12, v2, 4, v1
  v_add_u32 v12, 61440, v12
  v_mov_b32 v11, 0
  v_mov_b32 v13, 0
  v_lshl_add_u64 v[10:11], v[10:11], 0, s[10:11]
  v_lshl_add_u64 v[12:13], v[12:13], 0, s[10:11]
  s_cmp_lg_u32 s39, 147456
  s_cselect_b64 vcc, -1, 0
  s_mov_b32 s10, 122880
  s_mov_b32 s11, 0
  s_add_u32 m0, s37, 0
  s_nop 0
  global_load_lds_dwordx4 v[10:11], off nt
  s_add_u32 m0, m0, 1024
  v_lshl_add_u64 v[10:11], v[10:11], 0, s[10:11]
  global_load_lds_dwordx4 v[12:13], off nt
  s_add_u32 m0, m0, 1024
  v_lshl_add_u64 v[12:13], v[12:13], 0, s[10:11]
  s_cbranch_vccz L7_np
  s_waitcnt vmcnt(1)
L7_np:
  global_load_lds_dwordx4 v[10:11], off nt
  s_add_u32 m0, m0, 1024
  v_lshl_add_u64 v[10:11], v[10:11], 0, s[10:11]
  s_cbranch_vccz L8_np
  s_waitcnt vmcnt(1)
L8_np:
  global_load_lds_dwordx4 v[12:13], off nt
  s_add_u32 m0, m0, 1024
  v_lshl_add_u64 v[12:13], v[12:13], 0, s[10:11]
  s_cbranch_vccz L9_np
  s_waitcnt vmcnt(1)
L9_np:
  global_load_lds_dwordx4 v[10:11], off nt
  s_add_u32 m0, m0, 1024
  v_lshl_add_u64 v[10:11], v[10:11], 0, s[10:11]
  s_cbranch_vccz L10_np
  s_waitcnt vmcnt(1)
L10_np:
  global_load_lds_dwordx4 v[12:13], off nt
  s_add_u32 m0, m0, 1024
  v_lshl_add_u64 v[12:13], v[12:13], 0, s[10:11]
  s_cbranch_vccz L11_np
  s_waitcnt vmcnt(1)
L11_np:
  global_load_lds_dwordx4 v[10:11], off nt
  s_add_u32 m0, m0, 1024
  v_lshl_add_u64 v[10:11], v[10:11], 0, s[10:11]
  s_cbranch_vccz L12_np
  s_waitcnt vmcnt(1)
L12_np:
  global_load_lds_dwordx4 v[12:13], off nt
  s_add_u32 m0, m0, 1024
  v_lshl_add_u64 v[12:13], v[12:13], 0, s[10:11]
  s_cbranch_vccz L13_np
  s_waitcnt vmcnt(1)
L13_np:
  global_load_lds_dwordx4 v[10:11], off nt
  s_add_u32 m0, m0, 1024
  v_lshl_add_u64 v[10:11], v[10:11], 0, s[10:11]
  s_cbranch_vccz L14_np
  s_waitcnt vmcnt(1)
L14_np:
  global_load_lds_dwordx4 v[12:13], off nt
  s_add_u32 m0, m0, 1024
  v_lshl_add_u64 v[12:13], v[12:13], 0, s[10:11]
  s_cbranch_vccz L15_np
  s_waitcnt vmcnt(1)
L15_np:
  global_load_lds_dwordx4 v[10:11], off nt
  s_add_u32 m0, m0, 1024
  v_lshl_add_u64 v[10:11], v[10:11], 0, s[10:11]
  s_cbranch_vccz L16_np
  s_waitcnt vmcnt(1)
L16_np:
  global_load_lds_dwordx4 v[12:13], off nt
  s_add_u32 m0, m0, 1024
  v_lshl_add_u64 v[12:13], v[12:13], 0, s[10:11]
  s_cbranch_vccz L17_np
  s_waitcnt vmcnt(1)
L17_np:
  global_load_lds_dwordx4 v[10:11], off nt
  s_add_u32 m0, m0, 1024
  v_lshl_add_u64 v[10:11], v[10:11], 0, s[10:11]
  s_cbranch_vccz L18_np
  s_waitcnt vmcnt(1)
L18_np:
  global_load_lds_dwordx4 v[12:13], off nt
  s_add_u32 m0, m0, 1024
  v_lshl_add_u64 v[12:13], v[12:13], 0, s[10:11]
  s_cbranch_vccz L19_np
  s_waitcnt vmcnt(1)
L19_np:
  global_load_lds_dwordx4 v[10:11], off nt
  s_add_u32 m0, m0, 1024
  v_lshl_add_u64 v[10:11], v[10:11], 0, s[10:11]
  s_cbranch_vccz L20_np
  s_waitcnt vmcnt(1)
L20_np:
  global_load_lds_dwordx4 v[12:13], off nt
  s_add_u32 m0, m0, 1024
  v_lshl_add_u64 v[12:13], v[12:13], 0, s[10:11]
  s_cbranch_vccz L21_np
  s_waitcnt vmcnt(1)
L21_np:
  global_load_lds_dwordx4 v[10:11], off nt
  s_add_u32 m0, m0, 1024
  v_lshl_add_u64 v[10:11], v[10:11], 0, s[10:11]
  s_cbranch_vccz L22_np
  s_waitcnt vmcnt(1)
L22_np:
  global_load_lds_dwordx4 v[12:13], off nt
  s_add_u32 m0, m0, 1024
  v_lshl_add_u64 v[12:13], v[12:13], 0, s[10:11]
  s_cbranch_vccz L23_np
  s_waitcnt vmcnt(1)
L23_np:
  global_load_lds_dwordx4 v[10:11], off nt
  s_add_u32 m0, m0, 1024
  v_lshl_add_u64 v[10:11], v[10:11], 0, s[10:11]
  s_cbranch_vccz L24_np
  s_waitcnt vmcnt(1)
L24_np:
  global_load_lds_dwordx4 v[12:13], off nt
  s_add_u32 m0, m0, 1024
  v_lshl_add_u64 v[12:13], v[12:13], 0, s[10:11]
  s_cmp_lg_u32 s39, 147456
  s_cbranch_scc1 L25_nb
  s_barrier
L25_nb:
  v_bfe_u32 v1, v0, 2, 2
  v_and_b32 v2, 3, v0
  v_lshl_add_u32 v3, v20, 3, v1
  v_lshrrev_b32 v4, 1, v1
  v_and_b32 v5, 1, v20
  v_lshl_add_u32 v4, v5, 1, v4
  v_lshlrev_b32 v3, 7, v3
  v_lshl_add_u32 v3, v2, 3, v3
  v_add_u32 v3, s37, v3
  v_xor_b32 v5, 0, v4
  v_lshl_add_u32 v14, v5, 5, v3
  v_xor_b32 v5, 1, v4
  v_lshl_add_u32 v15, v5, 5, v3
  v_xor_b32 v5, 2, v4
  v_lshl_add_u32 v16, v5, 5, v3
  v_xor_b32 v5, 3, v4
  v_lshl_add_u32 v17, v5, 5, v3
  s_lshl_b32 s10, s38, 9
  s_add_u32 s10, s10, s39
  v_lshlrev_b32 v1, 8, v22
  v_lshl_add_u32 v1, v20, 4, v1
  v_add_u32 v24, s10, v1
  v_lshl_add_u32 v25, v0, 3, s39
  s_lshr_b32 s10, s39, 9
  s_add_u32 s10, s10, 153444
  v_mov_b32 v26, s10
  v_mov_b32 v27, 1
  s_mov_b32 s45, 3
  s_waitcnt vmcnt(20)
  v_and_b32 v33, 0xffff0000, v28
  v_lshlrev_b32 v32, 16, v28
  v_and_b32 v35, 0xffff0000, v29
  v_lshlrev_b32 v34, 16, v29
  v_and_b32 v37, 0xffff0000, v30
  v_lshlrev_b32 v36, 16, v30
  v_and_b32 v39, 0xffff0000, v31
  v_lshlrev_b32 v38, 16, v31
  v_mul_f32 v4, 0x3fb8aa3b, v32
  v_exp_f32 v4, -v4
  s_nop 0
  v_add_f32 v4, 1.0, v4
  v_rcp_f32 v5, v4
  s_nop 0
  v_mul_f32 v2, v32, v5
  v_fma_f32 v3, -v2, v4, v32
  v_fma_f32 v2, v3, v5, v2
  v_div_fixup_f32 v32, v2, v4, v32
  v_mul_f32 v4, 0x3fb8aa3b, v33
  v_exp_f32 v4, -v4
  s_nop 0
  v_add_f32 v4, 1.0, v4
  v_rcp_f32 v5, v4
  s_nop 0
  v_mul_f32 v2, v33, v5
  v_fma_f32 v3, -v2, v4, v33
  v_fma_f32 v2, v3, v5, v2
  v_div_fixup_f32 v33, v2, v4, v33
  v_mul_f32 v4, 0x3fb8aa3b, v34
  v_exp_f32 v4, -v4
  s_nop 0
  v_add_f32 v4, 1.0, v4
  v_rcp_f32 v5, v4
  s_nop 0
  v_mul_f32 v2, v34, v5
  v_fma_f32 v3, -v2, v4, v34
  v_fma_f32 v2, v3, v5, v2
  v_div_fixup_f32 v34, v2, v4, v34
  v_mul_f32 v4, 0x3fb8aa3b, v35
  v_exp_f32 v4, -v4
  s_nop 0
  v_add_f32 v4, 1.0, v4
  v_rcp_f32 v5, v4
  s_nop 0
  v_mul_f32 v2, v35, v5
  v_fma_f32 v3, -v2, v4, v35
  v_fma_f32 v2, v3, v5, v2
  v_div_fixup_f32 v35, v2, v4, v35
  v_mul_f32 v4, 0x3fb8aa3b, v36
  v_exp_f32 v4, -v4
  s_nop 0
  v_add_f32 v4, 1.0, v4
  v_rcp_f32 v5, v4
  s_nop 0
  v_mul_f32 v2, v36, v5
  v_fma_f32 v3, -v2, v4, v36
  v_fma_f32 v2, v3, v5, v2
  v_div_fixup_f32 v36, v2, v4, v36
  v_mul_f32 v4, 0x3fb8aa3b, v37
  v_exp_f32 v4, -v4
  s_nop 0
  v_add_f32 v4, 1.0, v4
  v_rcp_f32 v5, v4
  s_nop 0
  v_mul_f32 v2, v37, v5
  v_fma_f32 v3, -v2, v4, v37
  v_fma_f32 v2, v3, v5, v2
  v_div_fixup_f32 v37, v2, v4, v37
  v_mul_f32 v4, 0x3fb8aa3b, v38
  v_exp_f32 v4, -v4
  s_nop 0
  v_add_f32 v4, 1.0, v4
  v_rcp_f32 v5, v4
  s_nop 0
  v_mul_f32 v2, v38, v5
  v_fma_f32 v3, -v2, v4, v38
  v_fma_f32 v2, v3, v5, v2
  v_div_fixup_f32 v38, v2, v4, v38
  v_mul_f32 v4, 0x3fb8aa3b, v39
  v_exp_f32 v4, -v4
  s_nop 0
  v_add_f32 v4, 1.0, v4
  v_rcp_f32 v5, v4
  s_nop 0
  v_mul_f32 v2, v39, v5
  v_fma_f32 v3, -v2, v4, v39
  v_fma_f32 v2, v3, v5, v2
  v_div_fixup_f32 v39, v2, v4, v39
  v_cvt_pk_bf16_f32 v28, v32, v33
  v_cvt_pk_bf16_f32 v29, v34, v35
  v_cvt_pk_bf16_f32 v30, v36, v37
  v_cvt_pk_bf16_f32 v31, v38, v39
  v_and_b32 v8, 7, v0
  v_lshlrev_b32 v8, 2, v8
  global_load_dword v9, v8, s[88:89] sc1
  s_waitcnt vmcnt(17)
  ds_read_b64_tr_b16 v[128:129], v14 offset:0
  ds_read_b64_tr_b16 v[130:131], v14 offset:512
  ds_read_b64_tr_b16 v[132:133], v15 offset:0
  ds_read_b64_tr_b16 v[134:135], v15 offset:512
  ds_read_b64_tr_b16 v[136:137], v16 offset:0
  ds_read_b64_tr_b16 v[138:139], v16 offset:512
  ds_read_b64_tr_b16 v[140:141], v17 offset:0
  ds_read_b64_tr_b16 v[142:143], v17 offset:512
  s_waitcnt vmcnt(13)
  ds_read_b64_tr_b16 v[144:145], v14 offset:4096
  ds_read_b64_tr_b16 v[146:147], v14 offset:4608
  ds_read_b64_tr_b16 v[148:149], v15 offset:4096
  ds_read_b64_tr_b16 v[150:151], v15 offset:4608
  ds_read_b64_tr_b16 v[152:153], v16 offset:4096
  ds_read_b64_tr_b16 v[154:155], v16 offset:4608
  ds_read_b64_tr_b16 v[156:157], v17 offset:4096
  ds_read_b64_tr_b16 v[158:159], v17 offset:4608
  s_waitcnt vmcnt(9)
  ds_read_b64_tr_b16 v[160:161], v14 offset:8192
  ds_read_b64_tr_b16 v[162:163], v14 offset:8704
  ds_read_b64_tr_b16 v[164:165], v15 offset:8192
  ds_read_b64_tr_b16 v[166:167], v15 offset:8704
  ds_read_b64_tr_b16 v[168:169], v16 offset:8192
  ds_read_b64_tr_b16 v[170:171], v16 offset:8704
  ds_read_b64_tr_b16 v[172:173], v17 offset:8192
  ds_read_b64_tr_b16 v[174:175], v17 offset:8704
  s_waitcnt vmcnt(5)
  ds_read_b64_tr_b16 v[176:177], v14 offset:12288
  ds_read_b64_tr_b16 v[178:179], v14 offset:12800
  ds_read_b64_tr_b16 v[180:181], v15 offset:12288
  ds_read_b64_tr_b16 v[182:183], v15 offset:12800
  ds_read_b64_tr_b16 v[184:185], v16 offset:12288
  ds_read_b64_tr_b16 v[186:187], v16 offset:12800
  ds_read_b64_tr_b16 v[188:189], v17 offset:12288
  ds_read_b64_tr_b16 v[190:191], v17 offset:12800
  s_waitcnt vmcnt(1)
  ds_read_b64_tr_b16 v[192:193], v14 offset:16384
  ds_read_b64_tr_b16 v[194:195], v14 offset:16896
  ds_read_b64_tr_b16 v[196:197], v15 offset:16384
  ds_read_b64_tr_b16 v[198:199], v15 offset:16896
  ds_read_b64_tr_b16 v[200:201], v16 offset:16384
  ds_read_b64_tr_b16 v[202:203], v16 offset:16896
  ds_read_b64_tr_b16 v[204:205], v17 offset:16384
  ds_read_b64_tr_b16 v[206:207], v17 offset:16896
  s_waitcnt lgkmcnt(0)
  v_mfma_f32_16x16x32_bf16 v[96:99], v[128:131], v[28:31], 0
  v_mov_b32_dpp v116, v28 row_shl:2 row_mask:0xf bank_mask:0xf
  v_mov_b32_dpp v117, v29 row_shl:2 row_mask:0xf bank_mask:0xf
  v_mfma_f32_16x16x32_bf16 v[100:103], v[132:135], v[28:31], 0
  v_mov_b32_dpp v118, v30 row_shl:2 row_mask:0xf bank_mask:0xf
  v_mov_b32_dpp v119, v31 row_shl:2 row_mask:0xf bank_mask:0xf
  v_mfma_f32_16x16x32_bf16 v[104:107], v[136:139], v[28:31], 0
  v_mfma_f32_16x16x32_bf16 v[108:111], v[140:143], v[28:31], 0
  v_mfma_f32_16x16x32_bf16 v[96:99], v[144:147], v[116:119], v[96:99]
  v_mov_b32_dpp v112, v28 row_shl:4 row_mask:0xf bank_mask:0xf
  v_mov_b32_dpp v113, v29 row_shl:4 row_mask:0xf bank_mask:0xf
  v_mfma_f32_16x16x32_bf16 v[100:103], v[148:151], v[116:119], v[100:103]
  v_mov_b32_dpp v114, v30 row_shl:4 row_mask:0xf bank_mask:0xf
  v_mov_b32_dpp v115, v31 row_shl:4 row_mask:0xf bank_mask:0xf
  v_mfma_f32_16x16x32_bf16 v[104:107], v[152:155], v[116:119], v[104:107]
  v_mfma_f32_16x16x32_bf16 v[108:111], v[156:159], v[116:119], v[108:111]
  v_mfma_f32_16x16x32_bf16 v[96:99], v[160:163], v[112:115], v[96:99]
  v_mov_b32_dpp v116, v28 row_shl:6 row_mask:0xf bank_mask:0xf
  v_mov_b32_dpp v117, v29 row_shl:6 row_mask:0xf bank_mask:0xf
  v_mfma_f32_16x16x32_bf16 v[100:103], v[164:167], v[112:115], v[100:103]
  v_mov_b32_dpp v118, v30 row_shl:6 row_mask:0xf bank_mask:0xf
  v_mov_b32_dpp v119, v31 row_shl:6 row_mask:0xf bank_mask:0xf
  v_mfma_f32_16x16x32_bf16 v[104:107], v[168:171], v[112:115], v[104:107]
  v_mfma_f32_16x16x32_bf16 v[108:111], v[172:175], v[112:115], v[108:111]
  v_mfma_f32_16x16x32_bf16 v[96:99], v[176:179], v[116:119], v[96:99]
  v_mov_b32_dpp v112, v28 row_shl:8 row_mask:0xf bank_mask:0xf
  v_mov_b32_dpp v113, v29 row_shl:8 row_mask:0xf bank_mask:0xf
  v_mfma_f32_16x16x32_bf16 v[100:103], v[180:183], v[116:119], v[100:103]
  v_mov_b32_dpp v114, v30 row_shl:8 row_mask:0xf bank_mask:0xf
  v_mov_b32_dpp v115, v31 row_shl:8 row_mask:0xf bank_mask:0xf
  v_mfma_f32_16x16x32_bf16 v[104:107], v[184:187], v[116:119], v[104:107]
  v_mfma_f32_16x16x32_bf16 v[108:111], v[188:191], v[116:119], v[108:111]
  v_mfma_f32_16x16x32_bf16 v[96:99], v[192:195], v[112:115], v[96:99]
  v_mfma_f32_16x16x32_bf16 v[100:103], v[196:199], v[112:115], v[100:103]
  v_mfma_f32_16x16x32_bf16 v[104:107], v[200:203], v[112:115], v[104:107]
  v_mfma_f32_16x16x32_bf16 v[108:111], v[204:207], v[112:115], v[108:111]
  s_mov_b32 exec_lo, 0x00030003
  s_mov_b32 exec_hi, 0x00030003
  s_nop 2
  ds_write_b128 v24, v[96:99] offset:0
  ds_write_b128 v24, v[100:103] offset:64
  ds_write_b128 v24, v[104:107] offset:128
  ds_write_b128 v24, v[108:111] offset:192
  s_mov_b64 exec, 1
  ds_add_rtn_u32 v1, v26, v27
  s_mov_b64 exec, -1
  s_waitcnt lgkmcnt(0)
  v_readfirstlane_b32 s8, v1
  s_nop 0
  s_cmp_lg_u32 s8, s45
  s_cbranch_scc1 L_Mdone
  s_waitcnt vmcnt(0)
  v_cmp_eq_u32 vcc, 0, v9
  s_nop 0
  s_cbranch_vccz L26_fok
  s_mov_b32 s9, 262144
L27_flag:
  global_load_dword v9, v8, s[88:89] sc1
  s_waitcnt vmcnt(0)
  v_cmp_eq_u32 vcc, 0, v9
  s_nop 0
  s_cbranch_vccz L28_fdone
  s_sleep 8
  s_sub_u32 s9, s9, 1
  s_cbranch_scc0 L27_flag
L28_fdone:
L26_fok:
  ds_read_b64 v[96:97], v25 offset:0
  ds_read_b64 v[98:99], v25 offset:512
  ds_read_b64 v[100:101], v25 offset:1024
  ds_read_b64 v[102:103], v25 offset:1536
  s_lshl_b32 s10, s40, 8
  s_add_u32 s10, s10, 0
  v_lshl_add_u32 v1, v0, 2, s10
  s_waitcnt lgkmcnt(0)
  v_pk_add_f32 v[96:97], v[96:97], v[100:101]
  v_pk_add_f32 v[98:99], v[98:99], v[102:103]
  v_pk_add_f32 v[96:97], v[96:97], v[98:99]
  v_cvt_pk_bf16_f32 v2, v96, v97
  v_min_u32 v2, -2, v2
  buffer_store_dword v2, v1, s[4:7], 0 offen sc1
  s_mov_b64 exec, 1
  ds_add_u32 v26, v27
  s_mov_b64 exec, -1
L_Mdone:
  s_branch L_next
L_Q:
  v_mul_u32_u24 v1, 640, v22
  v_add_lshl_u32 v2, v1, v23, 1
  v_add_lshl_u32 v1, v1, v21, 1
  global_load_dwordx4 v[28:31], v2, s[64:65]
  global_load_dwordx4 v[32:35], v1, s[64:65] offset:0
  global_load_dwordx4 v[36:39], v1, s[64:65] offset:320
  global_load_dwordx4 v[40:43], v1, s[64:65] offset:640
  global_load_dwordx4 v[44:47], v1, s[64:65] offset:960
  s_lshl_b32 s12, s40, 7
  s_mul_i32 s10, s41, 12288
  s_add_u32 s10, s10, s12
  s_add_u32 s10, s70, s10
  s_addc_u32 s11, s71, 0
  v_mul_u32_u24 v1, 12288, v18
  v_lshl_add_u32 v10, v19, 4, v1
  v_xor_b32 v2, 4, v19
  v_lshl_add_u32 v12, v2, 4, v1
  v_add_u32 v12, 98304, v12
  v_mov_b32 v11, 0
  v_mov_b32 v13, 0
  v_lshl_add_u64 v[10:11], v[10:11], 0, s[10:11]
  v_lshl_add_u64 v[12:13], v[12:13], 0, s[10:11]
  s_mov_b32 s10, 196608
  s_mov_b32 s11, 0
  s_add_u32 m0, s37, 0
  s_nop 0
  global_load_lds_dwordx4 v[10:11], off nt
  s_add_u32 m0, m0, 1024
  v_lshl_add_u64 v[10:11], v[10:11], 0, s[10:11]
  global_load_lds_dwordx4 v[12:13], off nt
  s_add_u32 m0, m0, 1024
  v_lshl_add_u64 v[12:13], v[12:13], 0, s[10:11]
  global_load_lds_dwordx4 v[10:11], off nt
  s_add_u32 m0, m0, 1024
  v_lshl_add_u64 v[10:11], v[10:11], 0, s[10:11]
  global_load_lds_dwordx4 v[12:13], off nt
  s_add_u32 m0, m0, 1024
  v_lshl_add_u64 v[12:13], v[12:13], 0, s[10:11]
  global_load_lds_dwordx4 v[10:11], off nt
  s_add_u32 m0, m0, 1024
  v_lshl_add_u64 v[10:11], v[10:11], 0, s[10:11]
  global_load_lds_dwordx4 v[12:13], off nt
  s_add_u32 m0, m0, 1024
  v_lshl_add_u64 v[12:13], v[12:13], 0, s[10:11]
  global_load_lds_dwordx4 v[10:11], off nt
  s_add_u32 m0, m0, 1024
  v_lshl_add_u64 v[10:11], v[10:11], 0, s[10:11]
  global_load_lds_dwordx4 v[12:13], off nt
  s_add_u32 m0, m0, 1024
  v_lshl_add_u64 v[12:13], v[12:13], 0, s[10:11]
  global_load_lds_dwordx4 v[10:11], off nt
  s_add_u32 m0, m0, 1024
  v_lshl_add_u64 v[10:11], v[10:11], 0, s[10:11]
  global_load_lds_dwordx4 v[12:13], off nt
  s_add_u32 m0, m0, 1024
  v_lshl_add_u64 v[12:13], v[12:13], 0, s[10:11]
  global_load_lds_dwordx4 v[10:11], off nt
  s_add_u32 m0, m0, 1024
  v_lshl_add_u64 v[10:11], v[10:11], 0, s[10:11]
  global_load_lds_dwordx4 v[12:13], off nt
  s_add_u32 m0, m0, 1024
  v_lshl_add_u64 v[12:13], v[12:13], 0, s[10:11]
  global_load_lds_dwordx4 v[10:11], off nt
  s_add_u32 m0, m0, 1024
  v_lshl_add_u64 v[10:11], v[10:11], 0, s[10:11]
  global_load_lds_dwordx4 v[12:13], off nt
  s_add_u32 m0, m0, 1024
  v_lshl_add_u64 v[12:13], v[12:13], 0, s[10:11]
  global_load_lds_dwordx4 v[10:11], off nt
  s_add_u32 m0, m0, 1024
  v_lshl_add_u64 v[10:11], v[10:11], 0, s[10:11]
  global_load_lds_dwordx4 v[12:13], off nt
  s_add_u32 m0, m0, 1024
  v_lshl_add_u64 v[12:13], v[12:13], 0, s[10:11]
  global_load_lds_dwordx4 v[10:11], off nt
  s_add_u32 m0, m0, 1024
  v_lshl_add_u64 v[10:11], v[10:11], 0, s[10:11]
  global_load_lds_dwordx4 v[12:13], off nt
  s_add_u32 m0, m0, 1024
  v_lshl_add_u64 v[12:13], v[12:13], 0, s[10:11]
  global_load_lds_dwordx4 v[10:11], off nt
  s_add_u32 m0, m0, 1024
  v_lshl_add_u64 v[10:11], v[10:11], 0, s[10:11]
  global_load_lds_dwordx4 v[12:13], off nt
  s_add_u32 m0, m0, 1024
  v_lshl_add_u64 v[12:13], v[12:13], 0, s[10:11]
  s_cmp_lg_u32 s39, 147456
  s_cbranch_scc1 L29_nb
  s_barrier
L29_nb:
  v_bfe_u32 v1, v0, 2, 2
  v_and_b32 v2, 3, v0
  v_lshl_add_u32 v3, v20, 3, v1
  v_lshrrev_b32 v4, 1, v1
  v_and_b32 v5, 1, v20
  v_lshl_add_u32 v4, v5, 1, v4
  v_lshlrev_b32 v3, 7, v3
  v_lshl_add_u32 v3, v2, 3, v3
  v_add_u32 v3, s37, v3
  v_xor_b32 v5, 0, v4
  v_lshl_add_u32 v14, v5, 5, v3
  v_xor_b32 v5, 1, v4
  v_lshl_add_u32 v15, v5, 5, v3
  v_xor_b32 v5, 2, v4
  v_lshl_add_u32 v16, v5, 5, v3
  v_xor_b32 v5, 3, v4
  v_lshl_add_u32 v17, v5, 5, v3
  s_lshl_b32 s10, s38, 9
  s_add_u32 s10, s10, s39
  v_lshlrev_b32 v1, 8, v22
  v_lshl_add_u32 v1, v20, 4, v1
  v_add_u32 v24, s10, v1
  v_lshl_add_u32 v25, v0, 3, s39
  s_lshr_b32 s10, s39, 9
  s_add_u32 s10, s10, 153444
  v_mov_b32 v26, s10
  v_mov_b32 v27, 1
  s_mov_b32 s45, 3
  s_waitcnt vmcnt(20)
  v_and_b32 v49, 0xffff0000, v32
  v_lshlrev_b32 v48, 16, v32
  v_and_b32 v51, 0xffff0000, v33
  v_lshlrev_b32 v50, 16, v33
  v_and_b32 v53, 0xffff0000, v34
  v_lshlrev_b32 v52, 16, v34
  v_and_b32 v55, 0xffff0000, v35
  v_lshlrev_b32 v54, 16, v35
  v_and_b32 v57, 0xffff0000, v36
  v_lshlrev_b32 v56, 16, v36
  v_and_b32 v59, 0xffff0000, v37
  v_lshlrev_b32 v58, 16, v37
  v_and_b32 v61, 0xffff0000, v38
  v_lshlrev_b32 v60, 16, v38
  v_and_b32 v63, 0xffff0000, v39
  v_lshlrev_b32 v62, 16, v39
  v_and_b32 v65, 0xffff0000, v40
  v_lshlrev_b32 v64, 16, v40
  v_and_b32 v67, 0xffff0000, v41
  v_lshlrev_b32 v66, 16, v41
  v_and_b32 v69, 0xffff0000, v42
  v_lshlrev_b32 v68, 16, v42
  v_and_b32 v71, 0xffff0000, v43
  v_lshlrev_b32 v70, 16, v43
  v_and_b32 v73, 0xffff0000, v44
  v_lshlrev_b32 v72, 16, v44
  v_and_b32 v75, 0xffff0000, v45
  v_lshlrev_b32 v74, 16, v45
  v_and_b32 v77, 0xffff0000, v46
  v_lshlrev_b32 v76, 16, v46
  v_and_b32 v79, 0xffff0000, v47
  v_lshlrev_b32 v78, 16, v47
  v_and_b32 v33, 0xffff0000, v28
  v_lshlrev_b32 v32, 16, v28
  v_and_b32 v35, 0xffff0000, v29
  v_lshlrev_b32 v34, 16, v29
  v_and_b32 v37, 0xffff0000, v30
  v_lshlrev_b32 v36, 16, v30
  v_and_b32 v39, 0xffff0000, v31
  v_lshlrev_b32 v38, 16, v31
  v_pk_add_f32 v[80:81], v[48:49], v[64:65]
  v_pk_add_f32 v[82:83], v[50:51], v[66:67]
  v_pk_add_f32 v[84:85], v[52:53], v[68:69]
  v_pk_add_f32 v[86:87], v[54:55], v[70:71]
  v_pk_add_f32 v[88:89], v[56:57], v[72:73]
  v_pk_add_f32 v[90:91], v[58:59], v[74:75]
  v_pk_add_f32 v[92:93], v[60:61], v[76:77]
  v_pk_add_f32 v[94:95], v[62:63], v[78:79]
  v_pk_add_f32 v[80:81], v[80:81], v[88:89]
  v_pk_add_f32 v[82:83], v[82:83], v[90:91]
  v_pk_add_f32 v[84:85], v[84:85], v[92:93]
  v_pk_add_f32 v[86:87], v[86:87], v[94:95]
  v_pk_add_f32 v[80:81], v[80:81], v[84:85]
  v_pk_add_f32 v[82:83], v[82:83], v[86:87]
  v_pk_add_f32 v[80:81], v[80:81], v[82:83]
  v_add_f32 v6, v80, v81
  v_cndmask_b32 v6, 0, v6, s[16:17]
  s_nop 1
  v_add_f32_dpp v6, v6, v6 quad_perm:[2,3,0,1] row_mask:0xf bank_mask:0xf
  s_nop 1
  v_add_f32_dpp v6, v6, v6 row_ror:4 row_mask:0xf bank_mask:0xf
  s_nop 1
  v_add_f32_dpp v6, v6, v6 row_ror:8 row_mask:0xf bank_mask:0xf
  v_mov_b32 v1, v6
  s_nop 1
  v_permlane16_swap_b32 v6, v1
  v_add_f32 v6, v6, v1
  v_mov_b32 v1, v6
  s_nop 1
  v_permlane32_swap_b32 v6, v1
  v_add_f32 v6, v6, v1
  v_mul_f32 v6, 0x3acccccd, v6
  v_mov_b32 v8, 0
  v_sub_f32 v1, v48, v6
  v_fmac_f32 v8, v1, v1
  v_sub_f32 v1, v49, v6
  v_fmac_f32 v8, v1, v1
  v_sub_f32 v1, v50, v6
  v_fmac_f32 v8, v1, v1
  v_sub_f32 v1, v51, v6
  v_fmac_f32 v8, v1, v1
  v_sub_f32 v1, v52, v6
  v_fmac_f32 v8, v1, v1
  v_sub_f32 v1, v53, v6
  v_fmac_f32 v8, v1, v1
  v_sub_f32 v1, v54, v6
  v_fmac_f32 v8, v1, v1
  v_sub_f32 v1, v55, v6
  v_fmac_f32 v8, v1, v1
  v_sub_f32 v1, v56, v6
  v_fmac_f32 v8, v1, v1
  v_sub_f32 v1, v57, v6
  v_fmac_f32 v8, v1, v1
  v_sub_f32 v1, v58, v6
  v_fmac_f32 v8, v1, v1
  v_sub_f32 v1, v59, v6
  v_fmac_f32 v8, v1, v1
  v_sub_f32 v1, v60, v6
  v_fmac_f32 v8, v1, v1
  v_sub_f32 v1, v61, v6
  v_fmac_f32 v8, v1, v1
  v_sub_f32 v1, v62, v6
  v_fmac_f32 v8, v1, v1
  v_sub_f32 v1, v63, v6
  v_fmac_f32 v8, v1, v1
  v_sub_f32 v1, v64, v6
  v_fmac_f32 v8, v1, v1
  v_sub_f32 v1, v65, v6
  v_fmac_f32 v8, v1, v1
  v_sub_f32 v1, v66, v6
  v_fmac_f32 v8, v1, v1
  v_sub_f32 v1, v67, v6
  v_fmac_f32 v8, v1, v1
  v_sub_f32 v1, v68, v6
  v_fmac_f32 v8, v1, v1
  v_sub_f32 v1, v69, v6
  v_fmac_f32 v8, v1, v1
  v_sub_f32 v1, v70, v6
  v_fmac_f32 v8, v1, v1
  v_sub_f32 v1, v71, v6
  v_fmac_f32 v8, v1, v1
  v_sub_f32 v1, v72, v6
  v_fmac_f32 v8, v1, v1
  v_sub_f32 v1, v73, v6
  v_fmac_f32 v8, v1, v1
  v_sub_f32 v1, v74, v6
  v_fmac_f32 v8, v1, v1
  v_sub_f32 v1, v75, v6
  v_fmac_f32 v8, v1, v1
  v_sub_f32 v1, v76, v6
  v_fmac_f32 v8, v1, v1
  v_sub_f32 v1, v77, v6
  v_fmac_f32 v8, v1, v1
  v_sub_f32 v1, v78, v6
  v_fmac_f32 v8, v1, v1
  v_sub_f32 v1, v79, v6
  v_fmac_f32 v8, v1, v1
  v_cndmask_b32 v8, 0, v8, s[16:17]
  s_nop 1
  v_add_f32_dpp v8, v8, v8 quad_perm:[2,3,0,1] row_mask:0xf bank_mask:0xf
  s_nop 1
  v_add_f32_dpp v8, v8, v8 row_ror:4 row_mask:0xf bank_mask:0xf
  s_nop 1
  v_add_f32_dpp v8, v8, v8 row_ror:8 row_mask:0xf bank_mask:0xf
  v_mov_b32 v1, v8
  s_nop 1
  v_permlane16_swap_b32 v8, v1
  v_add_f32 v8, v8, v1
  v_mov_b32 v1, v8
  s_nop 1
  v_permlane32_swap_b32 v8, v1
  v_add_f32 v8, v8, v1
  v_mul_f32 v8, 0x3acccccd, v8
  v_cvt_pk_bf16_f32 v1, v6, v8
  v_and_b32 v8, 0xffff0000, v1
  v_add_f32 v8, 0x3727c5ac, v8
  v_cvt_pk_bf16_f32 v8, v8, v8
  v_lshlrev_b32 v8, 16, v8
  v_sqrt_f32 v8, v8
  v_lshlrev_b32 v6, 16, v1
  v_cvt_pk_bf16_f32 v8, v8, v8
  v_lshlrev_b32 v8, 16, v8
  v_rcp_f32 v8, v8
  v_pk_add_f32 v[32:33], v[32:33], v[6:7] op_sel_hi:[1,0] neg_lo:[0,1] neg_hi:[0,1]
  v_pk_add_f32 v[34:35], v[34:35], v[6:7] op_sel_hi:[1,0] neg_lo:[0,1] neg_hi:[0,1]
  v_pk_add_f32 v[36:37], v[36:37], v[6:7] op_sel_hi:[1,0] neg_lo:[0,1] neg_hi:[0,1]
  v_pk_add_f32 v[38:39], v[38:39], v[6:7] op_sel_hi:[1,0] neg_lo:[0,1] neg_hi:[0,1]
  v_cvt_pk_bf16_f32 v28, v32, v33
  v_cvt_pk_bf16_f32 v29, v34, v35
  v_cvt_pk_bf16_f32 v30, v36, v37
  v_cvt_pk_bf16_f32 v31, v38, v39
  v_and_b32 v33, 0xffff0000, v28
  v_lshlrev_b32 v32, 16, v28
  v_and_b32 v35, 0xffff0000, v29
  v_lshlrev_b32 v34, 16, v29
  v_and_b32 v37, 0xffff0000, v30
  v_lshlrev_b32 v36, 16, v30
  v_and_b32 v39, 0xffff0000, v31
  v_lshlrev_b32 v38, 16, v31
  v_pk_mul_f32 v[32:33], v[32:33], v[8:9] op_sel_hi:[1,0]
  v_pk_mul_f32 v[34:35], v[34:35], v[8:9] op_sel_hi:[1,0]
  v_pk_mul_f32 v[36:37], v[36:37], v[8:9] op_sel_hi:[1,0]
  v_pk_mul_f32 v[38:39], v[38:39], v[8:9] op_sel_hi:[1,0]
  v_cvt_pk_bf16_f32 v28, v32, v33
  v_cvt_pk_bf16_f32 v29, v34, v35
  v_cvt_pk_bf16_f32 v30, v36, v37
  v_cvt_pk_bf16_f32 v31, v38, v39
  v_and_b32 v33, 0xffff0000, v28
  v_lshlrev_b32 v32, 16, v28
  v_and_b32 v35, 0xffff0000, v29
  v_lshlrev_b32 v34, 16, v29
  v_and_b32 v37, 0xffff0000, v30
  v_lshlrev_b32 v36, 16, v30
  v_and_b32 v39, 0xffff0000, v31
  v_lshlrev_b32 v38, 16, v31
  v_and_b32 v8, 7, v0
  v_lshlrev_b32 v8, 2, v8
  global_load_dword v9, v8, s[88:89] sc1
  s_waitcnt vmcnt(17)
  ds_read_b64_tr_b16 v[128:129], v14 offset:0
  ds_read_b64_tr_b16 v[130:131], v14 offset:512
  ds_read_b64_tr_b16 v[132:133], v15 offset:0
  ds_read_b64_tr_b16 v[134:135], v15 offset:512
  ds_read_b64_tr_b16 v[136:137], v16 offset:0
  ds_read_b64_tr_b16 v[138:139], v16 offset:512
  ds_read_b64_tr_b16 v[140:141], v17 offset:0
  ds_read_b64_tr_b16 v[142:143], v17 offset:512
  s_waitcnt vmcnt(13)
  ds_read_b64_tr_b16 v[144:145], v14 offset:4096
  ds_read_b64_tr_b16 v[146:147], v14 offset:4608
  ds_read_b64_tr_b16 v[148:149], v15 offset:4096
  ds_read_b64_tr_b16 v[150:151], v15 offset:4608
  ds_read_b64_tr_b16 v[152:153], v16 offset:4096
  ds_read_b64_tr_b16 v[154:155], v16 offset:4608
  ds_read_b64_tr_b16 v[156:157], v17 offset:4096
  ds_read_b64_tr_b16 v[158:159], v17 offset:4608
  s_waitcnt vmcnt(9)
  ds_read_b64_tr_b16 v[160:161], v14 offset:8192
  ds_read_b64_tr_b16 v[162:163], v14 offset:8704
  ds_read_b64_tr_b16 v[164:165], v15 offset:8192
  ds_read_b64_tr_b16 v[166:167], v15 offset:8704
  ds_read_b64_tr_b16 v[168:169], v16 offset:8192
  ds_read_b64_tr_b16 v[170:171], v16 offset:8704
  ds_read_b64_tr_b16 v[172:173], v17 offset:8192
  ds_read_b64_tr_b16 v[174:175], v17 offset:8704
  s_waitcnt vmcnt(5)
  ds_read_b64_tr_b16 v[176:177], v14 offset:12288
  ds_read_b64_tr_b16 v[178:179], v14 offset:12800
  ds_read_b64_tr_b16 v[180:181], v15 offset:12288
  ds_read_b64_tr_b16 v[182:183], v15 offset:12800
  ds_read_b64_tr_b16 v[184:185], v16 offset:12288
  ds_read_b64_tr_b16 v[186:187], v16 offset:12800
  ds_read_b64_tr_b16 v[188:189], v17 offset:12288
  ds_read_b64_tr_b16 v[190:191], v17 offset:12800
  s_waitcnt vmcnt(1)
  ds_read_b64_tr_b16 v[192:193], v14 offset:16384
  ds_read_b64_tr_b16 v[194:195], v14 offset:16896
  ds_read_b64_tr_b16 v[196:197], v15 offset:16384
  ds_read_b64_tr_b16 v[198:199], v15 offset:16896
  ds_read_b64_tr_b16 v[200:201], v16 offset:16384
  ds_read_b64_tr_b16 v[202:203], v16 offset:16896
  ds_read_b64_tr_b16 v[204:205], v17 offset:16384
  ds_read_b64_tr_b16 v[206:207], v17 offset:16896
  s_waitcnt lgkmcnt(0)
  s_waitcnt vmcnt(0)
  v_cmp_eq_u32 vcc, 0, v9
  s_nop 0
  s_cbranch_vccz L30_fok
  s_mov_b32 s9, 262144
L31_flag:
  global_load_dword v9, v8, s[88:89] sc1
  s_waitcnt vmcnt(0)
  v_cmp_eq_u32 vcc, 0, v9
  s_nop 0
  s_cbranch_vccz L32_fdone
  s_sleep 8
  s_sub_u32 s9, s9, 1
  s_cbranch_scc0 L31_flag
L32_fdone:
L30_fok:
  v_lshrrev_b32 v1, 6, v23
  v_lshl_add_u32 v1, v1, 1, v22
  v_lshlrev_b32 v1, 6, v1
  v_and_b32 v2, 63, v23
  v_add_lshl_u32 v8, v1, v2, 1
  s_and_b32 s10, s40, 7
  s_cmp_eq_u32 s10, 3
  s_cbranch_scc1 L_Qgo
  v_mov_b32 v1, 153728
  s_mov_b32 s9, 2097152
L33_lw:
  ds_read_b32 v2, v1 offset:20
  s_waitcnt lgkmcnt(0)
  v_readfirstlane_b32 s8, v2
  s_nop 0
  s_cmp_ge_u32 s8, 2
  s_cbranch_scc1 L34_lwd
  s_sleep 4
  s_sub_u32 s9, s9, 1
  s_cbranch_scc0 L33_lw
L34_lwd:
L_Qgo:
  s_mov_b32 s9, 262144
L35_poll:
  buffer_load_dwordx4 v[40:43], v8, s[4:7], 0 offen sc1
  buffer_load_dwordx4 v[44:47], v8, s[4:7], 0 offen offset:2560 sc1
  s_waitcnt vmcnt(0)
  v_max3_u32 v1, v40, v41, v42
  v_max3_u32 v1, v1, v43, v44
  v_max3_u32 v1, v1, v45, v46
  v_max_u32 v1, v1, v47
  v_cmp_eq_u32 vcc, -1, v1
  s_nop 0
  s_cbranch_vccz L36_pdone
  s_mov_b64 exec, vcc
  s_sleep 8
  s_sub_u32 s9, s9, 1
  s_cbranch_scc0 L35_poll
L36_pdone:
  s_mov_b64 exec, -1
  v_and_b32 v57, 0xffff0000, v44
  v_lshlrev_b32 v56, 16, v44
  v_and_b32 v59, 0xffff0000, v45
  v_lshlrev_b32 v58, 16, v45
  v_and_b32 v61, 0xffff0000, v46
  v_lshlrev_b32 v60, 16, v46
  v_and_b32 v63, 0xffff0000, v47
  v_lshlrev_b32 v62, 16, v47
  v_pk_add_f32 v[56:57], v[56:57], 1.0 op_sel_hi:[1,0]
  v_pk_add_f32 v[58:59], v[58:59], 1.0 op_sel_hi:[1,0]
  v_pk_add_f32 v[60:61], v[60:61], 1.0 op_sel_hi:[1,0]
  v_pk_add_f32 v[62:63], v[62:63], 1.0 op_sel_hi:[1,0]
  v_cvt_pk_bf16_f32 v28, v56, v57
  v_cvt_pk_bf16_f32 v29, v58, v59
  v_cvt_pk_bf16_f32 v30, v60, v61
  v_cvt_pk_bf16_f32 v31, v62, v63
  v_and_b32 v57, 0xffff0000, v28
  v_lshlrev_b32 v56, 16, v28
  v_and_b32 v59, 0xffff0000, v29
  v_lshlrev_b32 v58, 16, v29
  v_and_b32 v61, 0xffff0000, v30
  v_lshlrev_b32 v60, 16, v30
  v_and_b32 v63, 0xffff0000, v31
  v_lshlrev_b32 v62, 16, v31
  v_pk_mul_f32 v[32:33], v[32:33], v[56:57]
  v_pk_mul_f32 v[34:35], v[34:35], v[58:59]
  v_pk_mul_f32 v[36:37], v[36:37], v[60:61]
  v_pk_mul_f32 v[38:39], v[38:39], v[62:63]
  v_cvt_pk_bf16_f32 v28, v32, v33
  v_cvt_pk_bf16_f32 v29, v34, v35
  v_cvt_pk_bf16_f32 v30, v36, v37
  v_cvt_pk_bf16_f32 v31, v38, v39
  v_and_b32 v33, 0xffff0000, v28
  v_lshlrev_b32 v32, 16, v28
  v_and_b32 v35, 0xffff0000, v29
  v_lshlrev_b32 v34, 16, v29
  v_and_b32 v37, 0xffff0000, v30
  v_lshlrev_b32 v36, 16, v30
  v_and_b32 v39, 0xffff0000, v31
  v_lshlrev_b32 v38, 16, v31
  v_and_b32 v49, 0xffff0000, v40
  v_lshlrev_b32 v48, 16, v40
  v_and_b32 v51, 0xffff0000, v41
  v_lshlrev_b32 v50, 16, v41
  v_and_b32 v53, 0xffff0000, v42
  v_lshlrev_b32 v52, 16, v42
  v_and_b32 v55, 0xffff0000, v43
  v_lshlrev_b32 v54, 16, v43
  v_pk_add_f32 v[32:33], v[32:33], v[48:49]
  v_pk_add_f32 v[34:35], v[34:35], v[50:51]
  v_pk_add_f32 v[36:37], v[36:37], v[52:53]
  v_pk_add_f32 v[38:39], v[38:39], v[54:55]
  v_cvt_pk_bf16_f32 v28, v32, v33
  v_cvt_pk_bf16_f32 v29, v34, v35
  v_cvt_pk_bf16_f32 v30, v36, v37
  v_cvt_pk_bf16_f32 v31, v38, v39
  s_nop 1
  v_mfma_f32_16x16x32_bf16 v[96:99], v[128:131], v[28:31], 0
  v_mov_b32_dpp v116, v28 row_shl:2 row_mask:0xf bank_mask:0xf
  v_mov_b32_dpp v117, v29 row_shl:2 row_mask:0xf bank_mask:0xf
  v_mfma_f32_16x16x32_bf16 v[100:103], v[132:135], v[28:31], 0
  v_mov_b32_dpp v118, v30 row_shl:2 row_mask:0xf bank_mask:0xf
  v_mov_b32_dpp v119, v31 row_shl:2 row_mask:0xf bank_mask:0xf
  v_mfma_f32_16x16x32_bf16 v[104:107], v[136:139], v[28:31], 0
  v_mfma_f32_16x16x32_bf16 v[108:111], v[140:143], v[28:31], 0
  v_mfma_f32_16x16x32_bf16 v[96:99], v[144:147], v[116:119], v[96:99]
  v_mov_b32_dpp v112, v28 row_shl:4 row_mask:0xf bank_mask:0xf
  v_mov_b32_dpp v113, v29 row_shl:4 row_mask:0xf bank_mask:0xf
  v_mfma_f32_16x16x32_bf16 v[100:103], v[148:151], v[116:119], v[100:103]
  v_mov_b32_dpp v114, v30 row_shl:4 row_mask:0xf bank_mask:0xf
  v_mov_b32_dpp v115, v31 row_shl:4 row_mask:0xf bank_mask:0xf
  v_mfma_f32_16x16x32_bf16 v[104:107], v[152:155], v[116:119], v[104:107]
  v_mfma_f32_16x16x32_bf16 v[108:111], v[156:159], v[116:119], v[108:111]
  v_mfma_f32_16x16x32_bf16 v[96:99], v[160:163], v[112:115], v[96:99]
  v_mov_b32_dpp v116, v28 row_shl:6 row_mask:0xf bank_mask:0xf
  v_mov_b32_dpp v117, v29 row_shl:6 row_mask:0xf bank_mask:0xf
  v_mfma_f32_16x16x32_bf16 v[100:103], v[164:167], v[112:115], v[100:103]
  v_mov_b32_dpp v118, v30 row_shl:6 row_mask:0xf bank_mask:0xf
  v_mov_b32_dpp v119, v31 row_shl:6 row_mask:0xf bank_mask:0xf
  v_mfma_f32_16x16x32_bf16 v[104:107], v[168:171], v[112:115], v[104:107]
  v_mfma_f32_16x16x32_bf16 v[108:111], v[172:175], v[112:115], v[108:111]
  v_mfma_f32_16x16x32_bf16 v[96:99], v[176:179], v[116:119], v[96:99]
  v_mov_b32_dpp v112, v28 row_shl:8 row_mask:0xf bank_mask:0xf
  v_mov_b32_dpp v113, v29 row_shl:8 row_mask:0xf bank_mask:0xf
  v_mfma_f32_16x16x32_bf16 v[100:103], v[180:183], v[116:119], v[100:103]
  v_mov_b32_dpp v114, v30 row_shl:8 row_mask:0xf bank_mask:0xf
  v_mov_b32_dpp v115, v31 row_shl:8 row_mask:0xf bank_mask:0xf
  v_mfma_f32_16x16x32_bf16 v[104:107], v[184:187], v[116:119], v[104:107]
  v_mfma_f32_16x16x32_bf16 v[108:111], v[188:191], v[116:119], v[108:111]
  v_mfma_f32_16x16x32_bf16 v[96:99], v[192:195], v[112:115], v[96:99]
  v_mfma_f32_16x16x32_bf16 v[100:103], v[196:199], v[112:115], v[100:103]
  v_mfma_f32_16x16x32_bf16 v[104:107], v[200:203], v[112:115], v[104:107]
  v_mfma_f32_16x16x32_bf16 v[108:111], v[204:207], v[112:115], v[108:111]
  s_mov_b32 exec_lo, 0x00030003
  s_mov_b32 exec_hi, 0x00030003
  s_nop 2
  ds_write_b128 v24, v[96:99] offset:0
  ds_write_b128 v24, v[100:103] offset:64
  ds_write_b128 v24, v[104:107] offset:128
  ds_write_b128 v24, v[108:111] offset:192
  s_mov_b64 exec, 1
  ds_add_rtn_u32 v1, v26, v27
  s_mov_b64 exec, -1
  s_waitcnt lgkmcnt(0)
  v_readfirstlane_b32 s8, v1
  s_nop 0
  s_cmp_lg_u32 s8, s45
  s_cbranch_scc1 L_next
  ds_read_b64 v[96:97], v25 offset:0
  ds_read_b64 v[98:99], v25 offset:512
  ds_read_b64 v[100:101], v25 offset:1024
  ds_read_b64 v[102:103], v25 offset:1536
  s_lshl_b32 s10, s40, 8
  s_add_u32 s10, s10, 16384
  v_lshl_add_u32 v1, v0, 2, s10
  s_waitcnt lgkmcnt(0)
  v_pk_add_f32 v[96:97], v[96:97], v[100:101]
  v_pk_add_f32 v[98:99], v[98:99], v[102:103]
  v_pk_add_f32 v[96:97], v[96:97], v[98:99]
  v_cvt_pk_bf16_f32 v2, v96, v97
  v_min_u32 v2, -2, v2
  buffer_store_dword v2, v1, s[4:7], 0 offen sc1
  s_mov_b64 exec, 1
  ds_add_u32 v26, v27
  s_mov_b64 exec, -1
  s_branch L_next
L_W:
  s_and_b32 s42, s40, 7
  s_lshr_b32 s43, s40, 3
  s_sub_u32 s13, 3, s38
  s_lshl3_add_u32 s13, s13, s42
  s_mul_i32 s13, s13, 192
  s_lshl_b32 s12, s43, 7
  s_mul_i32 s10, s13, 1280
  s_add_u32 s10, s10, s12
  s_add_u32 s10, s72, s10
  s_addc_u32 s11, s73, 0
  v_mul_u32_u24 v1, 1280, v18
  v_lshl_add_u32 v10, v19, 4, v1
  v_xor_b32 v2, 4, v19
  v_lshl_add_u32 v12, v2, 4, v1
  v_add_u32 v12, 10240, v12
  v_mov_b32 v11, 0
  v_mov_b32 v13, 0
  v_lshl_add_u64 v[10:11], v[10:11], 0, s[10:11]
  v_lshl_add_u64 v[12:13], v[12:13], 0, s[10:11]
  s_cmp_lg_u32 s39, 147456
  s_cselect_b64 vcc, -1, 0
  s_mov_b32 s10, 20480
  s_mov_b32 s11, 0
  s_add_u32 m0, s37, 0
  s_nop 0
  global_load_lds_dwordx4 v[10:11], off nt
  s_add_u32 m0, m0, 1024
  v_lshl_add_u64 v[10:11], v[10:11], 0, s[10:11]
  global_load_lds_dwordx4 v[12:13], off nt
  s_add_u32 m0, m0, 1024
  v_lshl_add_u64 v[12:13], v[12:13], 0, s[10:11]
  global_load_lds_dwordx4 v[10:11], off nt
  s_add_u32 m0, m0, 1024
  v_lshl_add_u64 v[10:11], v[10:11], 0, s[10:11]
  global_load_lds_dwordx4 v[12:13], off nt
  s_add_u32 m0, m0, 1024
  v_lshl_add_u64 v[12:13], v[12:13], 0, s[10:11]
  global_load_lds_dwordx4 v[10:11], off nt
  s_add_u32 m0, m0, 1024
  v_lshl_add_u64 v[10:11], v[10:11], 0, s[10:11]
  global_load_lds_dwordx4 v[12:13], off nt
  s_add_u32 m0, m0, 1024
  v_lshl_add_u64 v[12:13], v[12:13], 0, s[10:11]
  global_load_lds_dwordx4 v[10:11], off nt
  s_add_u32 m0, m0, 1024
  v_lshl_add_u64 v[10:11], v[10:11], 0, s[10:11]
  global_load_lds_dwordx4 v[12:13], off nt
  s_add_u32 m0, m0, 1024
  v_lshl_add_u64 v[12:13], v[12:13], 0, s[10:11]
  s_cbranch_vccz L37_np
  s_waitcnt vmcnt(7)
L37_np:
  global_load_lds_dwordx4 v[10:11], off nt
  s_add_u32 m0, m0, 1024
  v_lshl_add_u64 v[10:11], v[10:11], 0, s[10:11]
  s_cbranch_vccz L38_np
  s_waitcnt vmcnt(7)
L38_np:
  global_load_lds_dwordx4 v[12:13], off nt
  s_add_u32 m0, m0, 1024
  v_lshl_add_u64 v[12:13], v[12:13], 0, s[10:11]
  s_cbranch_vccz L39_np
  s_waitcnt vmcnt(7)
L39_np:
  global_load_lds_dwordx4 v[10:11], off nt
  s_add_u32 m0, m0, 1024
  v_lshl_add_u64 v[10:11], v[10:11], 0, s[10:11]
  s_cbranch_vccz L40_np
  s_waitcnt vmcnt(7)
L40_np:
  global_load_lds_dwordx4 v[12:13], off nt
  s_add_u32 m0, m0, 1024
  v_lshl_add_u64 v[12:13], v[12:13], 0, s[10:11]
  s_cbranch_vccz L41_np
  s_waitcnt vmcnt(7)
L41_np:
  global_load_lds_dwordx4 v[10:11], off nt
  s_add_u32 m0, m0, 1024
  v_lshl_add_u64 v[10:11], v[10:11], 0, s[10:11]
  s_cbranch_vccz L42_np
  s_waitcnt vmcnt(7)
L42_np:
  global_load_lds_dwordx4 v[12:13], off nt
  s_add_u32 m0, m0, 1024
  v_lshl_add_u64 v[12:13], v[12:13], 0, s[10:11]
  s_cbranch_vccz L43_np
  s_waitcnt vmcnt(7)
L43_np:
  global_load_lds_dwordx4 v[10:11], off nt
  s_add_u32 m0, m0, 1024
  v_lshl_add_u64 v[10:11], v[10:11], 0, s[10:11]
  s_cbranch_vccz L44_np
  s_waitcnt vmcnt(7)
L44_np:
  global_load_lds_dwordx4 v[12:13], off nt
  s_add_u32 m0, m0, 1024
  v_lshl_add_u64 v[12:13], v[12:13], 0, s[10:11]
  s_cbranch_vccz L45_np
  s_waitcnt vmcnt(7)
L45_np:
  global_load_lds_dwordx4 v[10:11], off nt
  s_add_u32 m0, m0, 1024
  v_lshl_add_u64 v[10:11], v[10:11], 0, s[10:11]
  s_cbranch_vccz L46_np
  s_waitcnt vmcnt(7)
L46_np:
  global_load_lds_dwordx4 v[12:13], off nt
  s_add_u32 m0, m0, 1024
  v_lshl_add_u64 v[12:13], v[12:13], 0, s[10:11]
  s_cbranch_vccz L47_np
  s_waitcnt vmcnt(7)
L47_np:
  global_load_lds_dwordx4 v[10:11], off nt
  s_add_u32 m0, m0, 1024
  v_lshl_add_u64 v[10:11], v[10:11], 0, s[10:11]
  s_cbranch_vccz L48_np
  s_waitcnt vmcnt(7)
L48_np:
  global_load_lds_dwordx4 v[12:13], off nt
  s_add_u32 m0, m0, 1024
  v_lshl_add_u64 v[12:13], v[12:13], 0, s[10:11]
  s_cmp_lg_u32 s39, 147456
  s_cbranch_scc1 L49_nb
  s_barrier
L49_nb:
  s_cbranch_vccz L50_np
  s_waitcnt vmcnt(7)
L50_np:
  global_load_lds_dwordx4 v[10:11], off nt
  s_add_u32 m0, m0, 1024
  v_lshl_add_u64 v[10:11], v[10:11], 0, s[10:11]
  s_cbranch_vccz L51_np
  s_waitcnt vmcnt(7)
L51_np:
  global_load_lds_dwordx4 v[12:13], off nt
  s_add_u32 m0, m0, 1024
  v_lshl_add_u64 v[12:13], v[12:13], 0, s[10:11]
  s_cbranch_vccz L52_np
  s_waitcnt vmcnt(7)
L52_np:
  global_load_lds_dwordx4 v[10:11], off nt
  s_add_u32 m0, m0, 1024
  v_lshl_add_u64 v[10:11], v[10:11], 0, s[10:11]
  s_cbranch_vccz L53_np
  s_waitcnt vmcnt(7)
L53_np:
  global_load_lds_dwordx4 v[12:13], off nt
  s_add_u32 m0, m0, 1024
  v_lshl_add_u64 v[12:13], v[12:13], 0, s[10:11]
  v_bfe_u32 v1, v0, 2, 2
  v_and_b32 v2, 3, v0
  v_lshlrev_b32 v3, 1, v20
  v_lshl_add_u32 v3, v1, 3, v3
  v_and_b32 v4, 1, v20
  v_and_b32 v5, 1, v1
  v_lshl_add_u32 v4, v5, 1, v4
  v_lshlrev_b32 v3, 7, v3
  v_lshl_add_u32 v3, v2, 3, v3
  v_add_u32 v3, s37, v3
  v_xor_b32 v5, 0, v4
  v_lshl_add_u32 v14, v5, 5, v3
  v_xor_b32 v5, 1, v4
  v_lshl_add_u32 v15, v5, 5, v3
  v_xor_b32 v5, 2, v4
  v_lshl_add_u32 v16, v5, 5, v3
  v_xor_b32 v5, 3, v4
  v_lshl_add_u32 v17, v5, 5, v3
  s_lshl_b32 s10, s38, 9
  s_add_u32 s10, s10, s39
  v_lshlrev_b32 v1, 8, v22
  v_lshl_add_u32 v1, v20, 4, v1
  v_add_u32 v24, s10, v1
  v_lshl_add_u32 v25, v0, 3, s39
  s_lshr_b32 s10, s39, 9
  s_add_u32 s10, s10, 153444
  v_mov_b32 v26, s10
  v_mov_b32 v27, 1
  s_mov_b32 s45, 3
  s_mul_i32 s10, s42, 12288
  s_add_u32 s10, s10, 212992
  v_bfe_u32 v1, v0, 1, 3
  v_mul_u32_u24 v1, 384, v1
  v_lshl_add_u32 v1, v22, 4, v1
  v_lshl_add_u32 v1, v20, 5, v1
  v_add_u32 v28, s10, v1
  s_lshl_b32 s10, s38, 9
  s_add_u32 s10, s10, s39
  v_lshl_add_u32 v24, v0, 2, s10
  s_lshr_b32 s10, s42, 1
  s_lshl_b32 s10, s10, 14
  s_and_b32 s11, s42, 1
  s_mul_i32 s11, s11, 2560
  s_add_u32 s10, s10, s11
  s_lshl_b32 s11, s43, 8
  s_add_u32 s10, s10, s11
  s_add_u32 s10, s10, 147456
  v_bfe_u32 v1, v0, 2, 2
  v_bfe_u32 v3, v0, 4, 1
  v_lshl_add_u32 v1, v1, 1, v3
  v_lshrrev_b32 v3, 5, v0
  v_lshl_add_u32 v1, v1, 1, v3
  v_and_b32 v3, 3, v0
  v_lshl_add_u32 v1, v1, 2, v3
  v_lshl_add_u32 v29, v1, 2, s10
  s_lshl_b32 s10, s42, 10
  s_add_u32 s10, s10, 73728
  v_and_b32 v1, 31, v0
  v_lshl_add_u32 v30, v1, 2, s10
  s_waitcnt vmcnt(20)
  ds_read_b64_tr_b16 v[64:65], v14 offset:0
  ds_read_b64_tr_b16 v[66:67], v14 offset:128
  ds_read_b64_tr_b16 v[68:69], v15 offset:0
  ds_read_b64_tr_b16 v[70:71], v15 offset:128
  ds_read_b64_tr_b16 v[72:73], v16 offset:0
  ds_read_b64_tr_b16 v[74:75], v16 offset:128
  ds_read_b64_tr_b16 v[76:77], v17 offset:0
  ds_read_b64_tr_b16 v[78:79], v17 offset:128
  s_waitcnt vmcnt(16)
  ds_read_b64_tr_b16 v[80:81], v14 offset:4096
  ds_read_b64_tr_b16 v[82:83], v14 offset:4224
  ds_read_b64_tr_b16 v[84:85], v15 offset:4096
  ds_read_b64_tr_b16 v[86:87], v15 offset:4224
  ds_read_b64_tr_b16 v[88:89], v16 offset:4096
  ds_read_b64_tr_b16 v[90:91], v16 offset:4224
  ds_read_b64_tr_b16 v[92:93], v17 offset:4096
  ds_read_b64_tr_b16 v[94:95], v17 offset:4224
  s_waitcnt vmcnt(12)
  ds_read_b64_tr_b16 v[96:97], v14 offset:8192
  ds_read_b64_tr_b16 v[98:99], v14 offset:8320
  ds_read_b64_tr_b16 v[100:101], v15 offset:8192
  ds_read_b64_tr_b16 v[102:103], v15 offset:8320
  ds_read_b64_tr_b16 v[104:105], v16 offset:8192
  ds_read_b64_tr_b16 v[106:107], v16 offset:8320
  ds_read_b64_tr_b16 v[108:109], v17 offset:8192
  ds_read_b64_tr_b16 v[110:111], v17 offset:8320
  s_waitcnt vmcnt(8)
  ds_read_b64_tr_b16 v[112:113], v14 offset:12288
  ds_read_b64_tr_b16 v[114:115], v14 offset:12416
  ds_read_b64_tr_b16 v[116:117], v15 offset:12288
  ds_read_b64_tr_b16 v[118:119], v15 offset:12416
  ds_read_b64_tr_b16 v[120:121], v16 offset:12288
  ds_read_b64_tr_b16 v[122:123], v16 offset:12416
  ds_read_b64_tr_b16 v[124:125], v17 offset:12288
  ds_read_b64_tr_b16 v[126:127], v17 offset:12416
  s_waitcnt vmcnt(4)
  ds_read_b64_tr_b16 v[128:129], v14 offset:16384
  ds_read_b64_tr_b16 v[130:131], v14 offset:16512
  ds_read_b64_tr_b16 v[132:133], v15 offset:16384
  ds_read_b64_tr_b16 v[134:135], v15 offset:16512
  ds_read_b64_tr_b16 v[136:137], v16 offset:16384
  ds_read_b64_tr_b16 v[138:139], v16 offset:16512
  ds_read_b64_tr_b16 v[140:141], v17 offset:16384
  ds_read_b64_tr_b16 v[142:143], v17 offset:16512
  s_waitcnt vmcnt(0)
  ds_read_b64_tr_b16 v[144:145], v14 offset:20480
  ds_read_b64_tr_b16 v[146:147], v14 offset:20608
  ds_read_b64_tr_b16 v[148:149], v15 offset:20480
  ds_read_b64_tr_b16 v[150:151], v15 offset:20608
  ds_read_b64_tr_b16 v[152:153], v16 offset:20480
  ds_read_b64_tr_b16 v[154:155], v16 offset:20608
  ds_read_b64_tr_b16 v[156:157], v17 offset:20480
  ds_read_b64_tr_b16 v[158:159], v17 offset:20608
  s_waitcnt lgkmcnt(0)
  v_mov_b32 v1, 153740
  v_mov_b32 v2, 1
  s_mov_b64 exec, 1
  ds_add_u32 v1, v2
  s_mov_b64 exec, -1
  s_mov_b32 s9, 2097152
L54_hbar:
  ds_read_b32 v2, v1
  s_waitcnt lgkmcnt(0)
  v_cmp_ne_u32 vcc, 4, v2
  s_nop 0
  s_cbranch_vccz L55_hbard
  s_sleep 8
  s_sub_u32 s9, s9, 1
  s_cbranch_scc0 L54_hbar
L55_hbard:
  s_mov_b32 s37, 73728
  v_bfe_u32 v1, v0, 2, 2
  v_and_b32 v2, 3, v0
  v_lshlrev_b32 v3, 1, v20
  v_lshl_add_u32 v3, v1, 3, v3
  v_and_b32 v4, 1, v20
  v_and_b32 v5, 1, v1
  v_lshl_add_u32 v4, v5, 1, v4
  v_lshlrev_b32 v3, 7, v3
  v_lshl_add_u32 v3, v2, 3, v3
  v_add_u32 v3, s37, v3
  v_xor_b32 v5, 0, v4
  v_lshl_add_u32 v14, v5, 5, v3
  v_xor_b32 v5, 1, v4
  v_lshl_add_u32 v15, v5, 5, v3
  v_xor_b32 v5, 2, v4
  v_lshl_add_u32 v16, v5, 5, v3
  v_xor_b32 v5, 3, v4
  v_lshl_add_u32 v17, v5, 5, v3
  s_waitcnt vmcnt(8)
  ds_read_b64_tr_b16 v[208:209], v14 offset:12288
  ds_read_b64_tr_b16 v[210:211], v14 offset:12416
  ds_read_b64_tr_b16 v[212:213], v15 offset:12288
  ds_read_b64_tr_b16 v[214:215], v15 offset:12416
  ds_read_b64_tr_b16 v[216:217], v16 offset:12288
  ds_read_b64_tr_b16 v[218:219], v16 offset:12416
  ds_read_b64_tr_b16 v[220:221], v17 offset:12288
  ds_read_b64_tr_b16 v[222:223], v17 offset:12416
  s_waitcnt vmcnt(4)
  ds_read_b64_tr_b16 v[224:225], v14 offset:16384
  ds_read_b64_tr_b16 v[226:227], v14 offset:16512
  ds_read_b64_tr_b16 v[228:229], v15 offset:16384
  ds_read_b64_tr_b16 v[230:231], v15 offset:16512
  ds_read_b64_tr_b16 v[232:233], v16 offset:16384
  ds_read_b64_tr_b16 v[234:235], v16 offset:16512
  ds_read_b64_tr_b16 v[236:237], v17 offset:16384
  ds_read_b64_tr_b16 v[238:239], v17 offset:16512
  s_waitcnt vmcnt(0)
  ds_read_b64_tr_b16 v[240:241], v14 offset:20480
  ds_read_b64_tr_b16 v[242:243], v14 offset:20608
  ds_read_b64_tr_b16 v[244:245], v15 offset:20480
  ds_read_b64_tr_b16 v[246:247], v15 offset:20608
  ds_read_b64_tr_b16 v[248:249], v16 offset:20480
  ds_read_b64_tr_b16 v[250:251], v16 offset:20608
  ds_read_b64_tr_b16 v[252:253], v17 offset:20480
  ds_read_b64_tr_b16 v[254:255], v17 offset:20608
  s_waitcnt lgkmcnt(0)
  s_mov_b32 s46, 8192
  s_mov_b32 s6, 0
  s_mov_b32 s45, 0
  s_mov_b32 s44, 0
  s_mov_b32 s47, 0
  v_mov_b32 v27, 0
L_Wt:
  s_mov_b32 s9, 262144
  s_mov_b64 vcc, -1
L56_spoll:
  s_sub_u32 s9, s9, 1
  s_cbranch_scc1 L57_sdone
  s_mov_b64 exec, vcc
  buffer_load_dwordx4 v[8:11], v28, s[4:7], s47 offen offset:0 sc1
  buffer_load_dwordx4 v[12:15], v28, s[4:7], s47 offen offset:128 sc1
  buffer_load_dwordx4 v[16:19], v28, s[4:7], s47 offen offset:256 sc1
  s_mov_b64 exec, -1
  s_waitcnt vmcnt(2)
  v_mfma_f32_16x16x32_bf16 v[32:35], v[8:11], v[160:163], 0
  v_max3_u32 v1, v8, v9, v10
  v_max_u32 v1, v1, v11
  v_mfma_f32_16x16x32_bf16 v[36:39], v[8:11], v[176:179], 0
  s_waitcnt vmcnt(1)
  v_mfma_f32_16x16x32_bf16 v[32:35], v[12:15], v[192:195], v[32:35]
  v_max3_u32 v1, v1, v12, v13
  v_max3_u32 v1, v1, v14, v15
  v_mfma_f32_16x16x32_bf16 v[36:39], v[12:15], v[208:211], v[36:39]
  s_waitcnt vmcnt(0)
  v_mfma_f32_16x16x32_bf16 v[32:35], v[16:19], v[224:227], v[32:35]
  v_max3_u32 v1, v1, v16, v17
  v_max3_u32 v1, v1, v18, v19
  v_cmp_eq_u32 vcc, -1, v1
  v_mfma_f32_16x16x32_bf16 v[36:39], v[16:19], v[240:243], v[36:39]
  s_cbranch_vccnz L56_spoll
L57_sdone:
  v_mfma_f32_16x16x32_bf16 v[40:43], v[8:11], v[164:167], 0
  v_mfma_f32_16x16x32_bf16 v[44:47], v[8:11], v[180:183], 0
  v_mfma_f32_16x16x32_bf16 v[40:43], v[12:15], v[196:199], v[40:43]
  v_mfma_f32_16x16x32_bf16 v[44:47], v[12:15], v[212:215], v[44:47]
  v_mfma_f32_16x16x32_bf16 v[40:43], v[16:19], v[228:231], v[40:43]
  v_mfma_f32_16x16x32_bf16 v[44:47], v[16:19], v[244:247], v[44:47]
  v_mfma_f32_16x16x32_bf16 v[48:51], v[8:11], v[168:171], 0
  v_mfma_f32_16x16x32_bf16 v[52:55], v[8:11], v[184:187], 0
  v_add_f32 v32, v32, v34
  v_mfma_f32_16x16x32_bf16 v[48:51], v[12:15], v[200:203], v[48:51]
  v_add_f32 v37, v37, v39
  v_mfma_f32_16x16x32_bf16 v[52:55], v[12:15], v[216:219], v[52:55]
  v_add_f32 v32, v32, v37
  v_mfma_f32_16x16x32_bf16 v[48:51], v[16:19], v[232:235], v[48:51]
  v_mfma_f32_16x16x32_bf16 v[52:55], v[16:19], v[248:251], v[52:55]
  v_mfma_f32_16x16x32_bf16 v[56:59], v[8:11], v[172:175], 0
  v_mfma_f32_16x16x32_bf16 v[60:63], v[8:11], v[188:191], 0
  v_add_f32 v40, v40, v42
  v_mfma_f32_16x16x32_bf16 v[56:59], v[12:15], v[204:207], v[56:59]
  v_add_f32 v45, v45, v47
  v_mfma_f32_16x16x32_bf16 v[60:63], v[12:15], v[220:223], v[60:63]
  v_add_f32 v40, v40, v45
  v_mfma_f32_16x16x32_bf16 v[56:59], v[16:19], v[236:239], v[56:59]
  s_nop 0
  v_permlane16_swap_b32 v32, v40
  v_mfma_f32_16x16x32_bf16 v[60:63], v[16:19], v[252:255], v[60:63]
  v_add_f32 v40, v32, v40
  v_add_f32 v48, v48, v50
  v_add_f32 v53, v53, v55
  v_add_f32 v48, v48, v53
  s_nop 0
  v_add_f32 v56, v56, v58
  s_nop 1
  v_add_f32 v61, v61, v63
  v_add_f32 v56, v56, v61
  s_nop 1
  v_permlane16_swap_b32 v48, v56
  v_add_f32 v56, v48, v56
  s_sub_u32 s47, s47, 98304
  s_sub_u32 s44, s44, 1
  v_permlane32_swap_b32 v40, v56
  v_add_f32 v40, v40, v56
  v_add_f32 v40, v40, v4
  ds_write_b32 v24, v40
  v_mov_b32 v4, v5
  v_subrev_u32 v24, 256, v24
  s_cbranch_scc0 L_Wt2
  s_mov_b64 exec, 1
  ds_add_rtn_u32 v1, v26, v27
  s_mov_b64 exec, -1
  ds_read_b64 v[8:9], v25 offset:0
  ds_read_b64 v[10:11], v25 offset:512
  ds_read_b64 v[12:13], v25 offset:1024
  ds_read_b64 v[14:15], v25 offset:1536
  s_waitcnt lgkmcnt(4)
  v_readfirstlane_b32 s8, v1
  s_waitcnt lgkmcnt(0)
  v_pk_add_f32 v[8:9], v[8:9], v[12:13]
  v_pk_add_f32 v[10:11], v[10:11], v[14:15]
  v_pk_add_f32 v[8:9], v[8:9], v[10:11]
  s_cmp_lg_u32 s8, s45
  s_cbranch_scc1 L_end
  v_cvt_pk_bf16_f32 v2, v8, v9
  v_min_u32 v2, -2, v2
  buffer_store_dword v2, v29, s[4:7], 0 offen sc1
  buffer_store_dword v2, v29, s[4:7], s46 offen sc1
  s_cmp_lg_u32 s45, 0
  s_cbranch_scc1 L_Wend
  s_mov_b32 s6, 999424
  s_mov_b32 s45, 3
  v_mov_b32 v27, 1
  v_add_u32 v24, 512, v24
  v_mov_b32 v4, 0
  v_mov_b32 v5, 0
  s_setprio 0
  v_mov_b32 v1, 153752
  s_mov_b32 s9, 2097152
L58_wake:
  ds_read_b64 v[2:3], v1
  s_waitcnt lgkmcnt(0)
  v_cmp_gt_u32 vcc, 1, v3
  s_nop 0
  s_cbranch_vccz L59_awake
  s_sleep 16
  s_sub_u32 s9, s9, 1
  s_cbranch_scc0 L58_wake
L59_awake:
  v_and_b32 v8, 7, v0
  v_cmp_gt_u32 vcc, 32, v0
  s_nop 1
  v_cndmask_b32 v8, v0, v8, vcc
  v_lshlrev_b32 v8, 2, v8
  s_mov_b32 s9, 262144
L60_flag:
  global_load_dword v9, v8, s[88:89] sc1
  s_waitcnt vmcnt(0)
  v_cmp_eq_u32 vcc, 0, v9
  s_nop 0
  s_cbranch_vccz L61_fdone
  s_sleep 8
  s_sub_u32 s9, s9, 1
  s_cbranch_scc0 L60_flag
L61_fdone:
  s_mov_b32 s24, 3
  s_cmp_eq_u32 s38, 3
  s_cbranch_scc1 L_merge
L_back3:
  s_cmp_eq_u32 s38, 3
  s_cbranch_scc1 L_Wsh
  s_mov_b32 s44, s38
L_Wp:
  s_lshl2_add_u32 s12, s44, 2
  v_mov_b32 v1, 153728
  s_mov_b32 s9, 2097152
L62_lw:
  ds_read_b32 v2, v1 offset:36
  s_waitcnt lgkmcnt(0)
  v_readfirstlane_b32 s8, v2
  s_nop 0
  s_bitcmp1_b32 s8, s12
  s_cbranch_scc1 L63_lwd
  s_sleep 4
  s_sub_u32 s9, s9, 1
  s_cbranch_scc0 L62_lw
L63_lwd:
  s_lshl_b32 s12, s44, 7
  s_mov_b32 s9, 262144
L64_poll:
  buffer_load_dword v2, v30, s[4:7], s12 offen sc1
  s_waitcnt vmcnt(0)
  v_cmp_eq_u32 vcc, -1, v2
  s_nop 0
  s_cbranch_vccz L65_pdone
  s_sleep 16
  s_sub_u32 s9, s9, 1
  s_cbranch_scc0 L64_poll
L65_pdone:
  s_sub_u32 s47, 7, s44
  v_mov_b32 v1, 153728
  s_mov_b32 s9, 2097152
L66_lw:
  ds_read_b32 v2, v1 offset:40
  s_waitcnt lgkmcnt(0)
  v_readfirstlane_b32 s8, v2
  s_nop 0
  s_cmp_lg_u32 s8, 0
  s_cbranch_scc1 L67_lwd
  s_sleep 8
  s_sub_u32 s9, s9, 1
  s_cbranch_scc0 L66_lw
L67_lwd:
  s_mov_b32 s26, s8
  s_sub_u32 s10, 7, s38
  s_cmp_eq_u32 s26, 2
  s_cselect_b32 s47, s10, s47
  s_mul_i32 s20, s47, 98304
  s_add_u32 s21, s20, 3072
  s_add_u32 s22, s20, 6144
  s_add_u32 s23, s20, 9216
  buffer_load_dwordx4 v[160:163], v28, s[4:7], s20 offen offset:0 sc1
  buffer_load_dwordx4 v[164:167], v28, s[4:7], s20 offen offset:128 sc1
  buffer_load_dwordx4 v[168:171], v28, s[4:7], s20 offen offset:256 sc1
  buffer_load_dwordx4 v[172:175], v28, s[4:7], s21 offen offset:0 sc1
  buffer_load_dwordx4 v[176:179], v28, s[4:7], s21 offen offset:128 sc1
  buffer_load_dwordx4 v[180:183], v28, s[4:7], s21 offen offset:256 sc1
  buffer_load_dwordx4 v[184:187], v28, s[4:7], s22 offen offset:0 sc1
  buffer_load_dwordx4 v[188:191], v28, s[4:7], s22 offen offset:128 sc1
  buffer_load_dwordx4 v[192:195], v28, s[4:7], s22 offen offset:256 sc1
  buffer_load_dwordx4 v[196:199], v28, s[4:7], s23 offen offset:0 sc1
  buffer_load_dwordx4 v[200:203], v28, s[4:7], s23 offen offset:128 sc1
  buffer_load_dwordx4 v[204:207], v28, s[4:7], s23 offen offset:256 sc1
  s_waitcnt vmcnt(11)
  v_mfma_f32_16x16x32_bf16 v[32:35], v[160:163], v[64:67], 0
  v_mfma_f32_16x16x32_bf16 v[36:39], v[160:163], v[80:83], 0
  v_mfma_f32_16x16x32_bf16 v[40:43], v[160:163], v[68:71], 0
  v_mfma_f32_16x16x32_bf16 v[44:47], v[160:163], v[84:87], 0
  v_mfma_f32_16x16x32_bf16 v[48:51], v[160:163], v[72:75], 0
  v_mfma_f32_16x16x32_bf16 v[52:55], v[160:163], v[88:91], 0
  v_mfma_f32_16x16x32_bf16 v[56:59], v[160:163], v[76:79], 0
  v_mfma_f32_16x16x32_bf16 v[60:63], v[160:163], v[92:95], 0
  s_waitcnt vmcnt(10)
  v_mfma_f32_16x16x32_bf16 v[32:35], v[164:167], v[96:99], v[32:35]
  v_mfma_f32_16x16x32_bf16 v[36:39], v[164:167], v[112:115], v[36:39]
  v_mfma_f32_16x16x32_bf16 v[40:43], v[164:167], v[100:103], v[40:43]
  v_mfma_f32_16x16x32_bf16 v[44:47], v[164:167], v[116:119], v[44:47]
  v_mfma_f32_16x16x32_bf16 v[48:51], v[164:167], v[104:107], v[48:51]
  v_mfma_f32_16x16x32_bf16 v[52:55], v[164:167], v[120:123], v[52:55]
  v_mfma_f32_16x16x32_bf16 v[56:59], v[164:167], v[108:111], v[56:59]
  v_mfma_f32_16x16x32_bf16 v[60:63], v[164:167], v[124:127], v[60:63]
  s_waitcnt vmcnt(9)
  v_mfma_f32_16x16x32_bf16 v[32:35], v[168:171], v[128:131], v[32:35]
  v_mfma_f32_16x16x32_bf16 v[36:39], v[168:171], v[144:147], v[36:39]
  v_mfma_f32_16x16x32_bf16 v[40:43], v[168:171], v[132:135], v[40:43]
  v_mfma_f32_16x16x32_bf16 v[44:47], v[168:171], v[148:151], v[44:47]
  v_mfma_f32_16x16x32_bf16 v[48:51], v[168:171], v[136:139], v[48:51]
  v_mfma_f32_16x16x32_bf16 v[52:55], v[168:171], v[152:155], v[52:55]
  v_mfma_f32_16x16x32_bf16 v[56:59], v[168:171], v[140:143], v[56:59]
  v_mfma_f32_16x16x32_bf16 v[60:63], v[168:171], v[156:159], v[60:63]
  s_waitcnt vmcnt(8)
  v_mfma_f32_16x16x32_bf16 v[32:35], v[172:175], v[64:67], v[32:35]
  v_mfma_f32_16x16x32_bf16 v[36:39], v[172:175], v[80:83], v[36:39]
  v_mfma_f32_16x16x32_bf16 v[40:43], v[172:175], v[68:71], v[40:43]
  v_mfma_f32_16x16x32_bf16 v[44:47], v[172:175], v[84:87], v[44:47]
  v_mfma_f32_16x16x32_bf16 v[48:51], v[172:175], v[72:75], v[48:51]
  v_mfma_f32_16x16x32_bf16 v[52:55], v[172:175], v[88:91], v[52:55]
  v_mfma_f32_16x16x32_bf16 v[56:59], v[172:175], v[76:79], v[56:59]
  v_mfma_f32_16x16x32_bf16 v[60:63], v[172:175], v[92:95], v[60:63]
  s_waitcnt vmcnt(7)
  v_mfma_f32_16x16x32_bf16 v[32:35], v[176:179], v[96:99], v[32:35]
  v_mfma_f32_16x16x32_bf16 v[36:39], v[176:179], v[112:115], v[36:39]
  v_mfma_f32_16x16x32_bf16 v[40:43], v[176:179], v[100:103], v[40:43]
  v_mfma_f32_16x16x32_bf16 v[44:47], v[176:179], v[116:119], v[44:47]
  v_mfma_f32_16x16x32_bf16 v[48:51], v[176:179], v[104:107], v[48:51]
  v_mfma_f32_16x16x32_bf16 v[52:55], v[176:179], v[120:123], v[52:55]
  v_mfma_f32_16x16x32_bf16 v[56:59], v[176:179], v[108:111], v[56:59]
  v_mfma_f32_16x16x32_bf16 v[60:63], v[176:179], v[124:127], v[60:63]
  s_waitcnt vmcnt(6)
  v_mfma_f32_16x16x32_bf16 v[32:35], v[180:183], v[128:131], v[32:35]
  v_mfma_f32_16x16x32_bf16 v[36:39], v[180:183], v[144:147], v[36:39]
  v_mfma_f32_16x16x32_bf16 v[40:43], v[180:183], v[132:135], v[40:43]
  v_mfma_f32_16x16x32_bf16 v[44:47], v[180:183], v[148:151], v[44:47]
  v_mfma_f32_16x16x32_bf16 v[48:51], v[180:183], v[136:139], v[48:51]
  v_mfma_f32_16x16x32_bf16 v[52:55], v[180:183], v[152:155], v[52:55]
  v_mfma_f32_16x16x32_bf16 v[56:59], v[180:183], v[140:143], v[56:59]
  v_mfma_f32_16x16x32_bf16 v[60:63], v[180:183], v[156:159], v[60:63]
  s_waitcnt vmcnt(5)
  v_mfma_f32_16x16x32_bf16 v[32:35], v[184:187], v[64:67], v[32:35]
  v_mfma_f32_16x16x32_bf16 v[36:39], v[184:187], v[80:83], v[36:39]
  v_mfma_f32_16x16x32_bf16 v[40:43], v[184:187], v[68:71], v[40:43]
  v_mfma_f32_16x16x32_bf16 v[44:47], v[184:187], v[84:87], v[44:47]
  v_mfma_f32_16x16x32_bf16 v[48:51], v[184:187], v[72:75], v[48:51]
  v_mfma_f32_16x16x32_bf16 v[52:55], v[184:187], v[88:91], v[52:55]
  v_mfma_f32_16x16x32_bf16 v[56:59], v[184:187], v[76:79], v[56:59]
  v_mfma_f32_16x16x32_bf16 v[60:63], v[184:187], v[92:95], v[60:63]
  s_waitcnt vmcnt(4)
  v_mfma_f32_16x16x32_bf16 v[32:35], v[188:191], v[96:99], v[32:35]
  v_mfma_f32_16x16x32_bf16 v[36:39], v[188:191], v[112:115], v[36:39]
  v_mfma_f32_16x16x32_bf16 v[40:43], v[188:191], v[100:103], v[40:43]
  v_mfma_f32_16x16x32_bf16 v[44:47], v[188:191], v[116:119], v[44:47]
  v_mfma_f32_16x16x32_bf16 v[48:51], v[188:191], v[104:107], v[48:51]
  v_mfma_f32_16x16x32_bf16 v[52:55], v[188:191], v[120:123], v[52:55]
  v_mfma_f32_16x16x32_bf16 v[56:59], v[188:191], v[108:111], v[56:59]
  v_mfma_f32_16x16x32_bf16 v[60:63], v[188:191], v[124:127], v[60:63]
  s_waitcnt vmcnt(3)
  v_mfma_f32_16x16x32_bf16 v[32:35], v[192:195], v[128:131], v[32:35]
  v_mfma_f32_16x16x32_bf16 v[36:39], v[192:195], v[144:147], v[36:39]
  v_mfma_f32_16x16x32_bf16 v[40:43], v[192:195], v[132:135], v[40:43]
  v_mfma_f32_16x16x32_bf16 v[44:47], v[192:195], v[148:151], v[44:47]
  v_mfma_f32_16x16x32_bf16 v[48:51], v[192:195], v[136:139], v[48:51]
  v_mfma_f32_16x16x32_bf16 v[52:55], v[192:195], v[152:155], v[52:55]
  v_mfma_f32_16x16x32_bf16 v[56:59], v[192:195], v[140:143], v[56:59]
  v_mfma_f32_16x16x32_bf16 v[60:63], v[192:195], v[156:159], v[60:63]
  s_waitcnt vmcnt(2)
  v_mfma_f32_16x16x32_bf16 v[32:35], v[196:199], v[64:67], v[32:35]
  v_mfma_f32_16x16x32_bf16 v[36:39], v[196:199], v[80:83], v[36:39]
  v_mfma_f32_16x16x32_bf16 v[40:43], v[196:199], v[68:71], v[40:43]
  v_mfma_f32_16x16x32_bf16 v[44:47], v[196:199], v[84:87], v[44:47]
  v_mfma_f32_16x16x32_bf16 v[48:51], v[196:199], v[72:75], v[48:51]
  v_mfma_f32_16x16x32_bf16 v[52:55], v[196:199], v[88:91], v[52:55]
  v_mfma_f32_16x16x32_bf16 v[56:59], v[196:199], v[76:79], v[56:59]
  v_mfma_f32_16x16x32_bf16 v[60:63], v[196:199], v[92:95], v[60:63]
  s_waitcnt vmcnt(1)
  v_mfma_f32_16x16x32_bf16 v[32:35], v[200:203], v[96:99], v[32:35]
  v_mfma_f32_16x16x32_bf16 v[36:39], v[200:203], v[112:115], v[36:39]
  v_mfma_f32_16x16x32_bf16 v[40:43], v[200:203], v[100:103], v[40:43]
  v_mfma_f32_16x16x32_bf16 v[44:47], v[200:203], v[116:119], v[44:47]
  v_mfma_f32_16x16x32_bf16 v[48:51], v[200:203], v[104:107], v[48:51]
  v_mfma_f32_16x16x32_bf16 v[52:55], v[200:203], v[120:123], v[52:55]
  v_mfma_f32_16x16x32_bf16 v[56:59], v[200:203], v[108:111], v[56:59]
  v_mfma_f32_16x16x32_bf16 v[60:63], v[200:203], v[124:127], v[60:63]
  s_waitcnt vmcnt(0)
  v_mfma_f32_16x16x32_bf16 v[32:35], v[204:207], v[128:131], v[32:35]
  v_mfma_f32_16x16x32_bf16 v[36:39], v[204:207], v[144:147], v[36:39]
  v_mfma_f32_16x16x32_bf16 v[40:43], v[204:207], v[132:135], v[40:43]
  v_mfma_f32_16x16x32_bf16 v[44:47], v[204:207], v[148:151], v[44:47]
  v_mfma_f32_16x16x32_bf16 v[48:51], v[204:207], v[136:139], v[48:51]
  v_mfma_f32_16x16x32_bf16 v[52:55], v[204:207], v[152:155], v[52:55]
  v_mfma_f32_16x16x32_bf16 v[56:59], v[204:207], v[140:143], v[56:59]
  v_mfma_f32_16x16x32_bf16 v[60:63], v[204:207], v[156:159], v[60:63]
  s_cmp_lg_u32 s26, 2
  s_cbranch_scc1 L_Wnd
  s_mul_i32 s10, s38, 10
  s_add_u32 s10, s10, s43
  s_lshl2_add_u32 s10, s10, 896
  s_mov_b64 exec, 1
  buffer_store_dword v0, v30, s[4:7], s10 offen
  s_mov_b64 exec, -1
L_Wnd:
  v_add_f32 v32, v32, v34
  v_add_f32 v37, v37, v39
  v_add_f32 v32, v32, v37
  v_add_f32 v40, v40, v42
  v_add_f32 v45, v45, v47
  v_add_f32 v40, v40, v45
  s_nop 1
  v_permlane16_swap_b32 v32, v40
  v_add_f32 v40, v32, v40
  v_add_f32 v48, v48, v50
  v_add_f32 v53, v53, v55
  v_add_f32 v48, v48, v53
  v_add_f32 v56, v56, v58
  v_add_f32 v61, v61, v63
  v_add_f32 v56, v56, v61
  s_nop 1
  v_permlane16_swap_b32 v48, v56
  v_add_f32 v56, v48, v56
  s_nop 1
  v_permlane32_swap_b32 v40, v56
  v_mov_b32 v4, v5
  v_add_f32 v5, v40, v56
  s_mov_b32 s6, 999424
  s_add_u32 s44, s44, 3
  s_cmp_lt_u32 s44, 6
  s_cbranch_scc1 L_Wp
L_Wsh:
  v_mov_b32 v6, v4
  v_mov_b32 v7, v5
  s_mov_b32 s37, 73728
  v_bfe_u32 v1, v0, 2, 2
  v_and_b32 v2, 3, v0
  v_lshlrev_b32 v3, 1, v20
  v_lshl_add_u32 v3, v1, 3, v3
  v_and_b32 v4, 1, v20
  v_and_b32 v5, 1, v1
  v_lshl_add_u32 v4, v5, 1, v4
  v_lshlrev_b32 v3, 7, v3
  v_lshl_add_u32 v3, v2, 3, v3
  v_add_u32 v3, s37, v3
  v_xor_b32 v5, 0, v4
  v_lshl_add_u32 v14, v5, 5, v3
  v_xor_b32 v5, 1, v4
  v_lshl_add_u32 v15, v5, 5, v3
  v_xor_b32 v5, 2, v4
  v_lshl_add_u32 v16, v5, 5, v3
  v_xor_b32 v5, 3, v4
  v_lshl_add_u32 v17, v5, 5, v3
  s_waitcnt vmcnt(8)
  ds_read_b64_tr_b16 v[160:161], v14 offset:0
  ds_read_b64_tr_b16 v[162:163], v14 offset:128
  ds_read_b64_tr_b16 v[164:165], v15 offset:0
  ds_read_b64_tr_b16 v[166:167], v15 offset:128
  ds_read_b64_tr_b16 v[168:169], v16 offset:0
  ds_read_b64_tr_b16 v[170:171], v16 offset:128
  ds_read_b64_tr_b16 v[172:173], v17 offset:0
  ds_read_b64_tr_b16 v[174:175], v17 offset:128
  s_waitcnt vmcnt(4)
  ds_read_b64_tr_b16 v[176:177], v14 offset:4096
  ds_read_b64_tr_b16 v[178:179], v14 offset:4224
  ds_read_b64_tr_b16 v[180:181], v15 offset:4096
  ds_read_b64_tr_b16 v[182:183], v15 offset:4224
  ds_read_b64_tr_b16 v[184:185], v16 offset:4096
  ds_read_b64_tr_b16 v[186:187], v16 offset:4224
  ds_read_b64_tr_b16 v[188:189], v17 offset:4096
  ds_read_b64_tr_b16 v[190:191], v17 offset:4224
  s_waitcnt vmcnt(0)
  ds_read_b64_tr_b16 v[192:193], v14 offset:8192
  ds_read_b64_tr_b16 v[194:195], v14 offset:8320
  ds_read_b64_tr_b16 v[196:197], v15 offset:8192
  ds_read_b64_tr_b16 v[198:199], v15 offset:8320
  ds_read_b64_tr_b16 v[200:201], v16 offset:8192
  ds_read_b64_tr_b16 v[202:203], v16 offset:8320
  ds_read_b64_tr_b16 v[204:205], v17 offset:8192
  ds_read_b64_tr_b16 v[206:207], v17 offset:8320
  s_waitcnt lgkmcnt(0)
  v_mov_b32 v4, v6
  v_mov_b32 v5, v7
  v_mov_b32 v1, 153752
  v_mov_b32 v2, 1
  s_mov_b64 exec, 1
  ds_add_u32 v1, v2
  s_mov_b64 exec, -1
  s_mov_b32 s9, 2097152
L68_wake:
  ds_read_b64 v[2:3], v1
  s_waitcnt lgkmcnt(0)
  v_lshrrev_b32 v2, 2, v2
  v_mul_u32_u24 v3, v2, v3
  v_cmp_gt_u32 vcc, 64, v3
  s_nop 0
  s_cbranch_vccz L69_awake
  s_sleep 1
  s_sub_u32 s9, s9, 1
  s_cbranch_scc0 L68_wake
L69_awake:
  s_mul_i32 s47, s38, 3072
  s_add_u32 s47, s47, 98304
  s_mov_b32 s44, 1
  s_branch L_Wt
L_Wt2:
  s_branch L_Wt
L_Wend:
  s_endpgm
L_idle:
  s_cmp_lg_u32 s38, 3
  s_cbranch_scc1 L_end
  s_setprio 0
  v_mov_b32 v1, 153752
  s_mov_b32 s9, 2097152
L70_wake:
  ds_read_b64 v[2:3], v1
  s_waitcnt lgkmcnt(0)
  v_cmp_gt_u32 vcc, 1, v3
  s_nop 0
  s_cbranch_vccz L71_awake
  s_sleep 16
  s_sub_u32 s9, s9, 1
  s_cbranch_scc0 L70_wake
L71_awake:
  v_and_b32 v8, 7, v0
  v_cmp_gt_u32 vcc, 32, v0
  s_nop 1
  v_cndmask_b32 v8, v0, v8, vcc
  v_lshlrev_b32 v8, 2, v8
  s_mov_b32 s9, 262144
L72_flag:
  global_load_dword v9, v8, s[88:89] sc1
  s_waitcnt vmcnt(0)
  v_cmp_eq_u32 vcc, 0, v9
  s_nop 0
  s_cbranch_vccz L73_fdone
  s_sleep 8
  s_sub_u32 s9, s9, 1
  s_cbranch_scc0 L72_flag
L73_fdone:
  s_mov_b32 s24, 0
L_merge:
  v_mov_b32 v1, 153728
  s_mov_b32 s9, 2097152
L74_lw:
  ds_read_b32 v2, v1 offset:32
  s_waitcnt lgkmcnt(0)
  v_readfirstlane_b32 s8, v2
  s_nop 0
  s_cmp_eq_u32 s8, 4
  s_cbranch_scc1 L75_lwd
  s_sleep 8
  s_sub_u32 s9, s9, 1
  s_cbranch_scc0 L74_lw
L75_lwd:
  v_and_b32 v96, 31, v0
  v_lshlrev_b32 v1, 3, v96
  v_add_u32 v1, 153792, v1
  ds_read_b64 v[98:99], v1
  s_and_b32 s34, s2, 7
  s_lshr_b32 s35, s2, 3
  s_lshl_b32 s10, s34, 12
  s_add_u32 s10, s10, 81920
  v_lshrrev_b32 v1, 1, v0
  v_lshlrev_b32 v1, 7, v1
  v_add_u32 v97, s10, v1
  s_lshl_b32 s11, s35, 7
  s_add_u32 s10, s10, s11
  v_lshl_add_u32 v1, v0, 1, s10
  s_getreg_b32 s32, hwreg(HW_REG_XCC_ID, 0, 4)
  s_waitcnt lgkmcnt(0)
  v_mov_b32 v100, v98
  s_nop 1
  v_max_f32_dpp v100, v100, v100 quad_perm:[1,0,3,2] row_mask:0xf bank_mask:0xf
  s_nop 1
  v_max_f32_dpp v100, v100, v100 quad_perm:[2,3,0,1] row_mask:0xf bank_mask:0xf
  v_sub_f32 v101, v98, v100
  v_mul_f32 v101, 0x3fb8aa3b, v101
  v_exp_f32 v101, v101
  s_nop 0
  v_mul_f32 v101, v101, v99
  s_nop 1
  v_add_f32_dpp v101, v101, v101 quad_perm:[1,0,3,2] row_mask:0xf bank_mask:0xf
  s_nop 1
  v_add_f32_dpp v101, v101, v101 quad_perm:[2,3,0,1] row_mask:0xf bank_mask:0xf
  v_min_u32 v100, -2, v100
  v_min_u32 v101, -2, v101
  v_writelane_b32 v100, s32, 32
  s_mov_b32 exec_lo, 0x11111111
  s_mov_b32 exec_hi, 1
  buffer_store_dwordx2 v[100:101], v1, s[4:7], 0 offen sc1
  s_mov_b64 exec, -1
  v_mov_b32 v1, 153728
  s_mov_b32 s9, 2097152
L76_lw:
  ds_read_b32 v2, v1 offset:36
  s_waitcnt lgkmcnt(0)
  v_readfirstlane_b32 s8, v2
  s_nop 0
  s_bitcmp1_b32 s8, 2
  s_cbranch_scc1 L77_lwd
  s_sleep 4
  s_sub_u32 s9, s9, 1
  s_cbranch_scc0 L76_lw
L77_lwd:
  v_and_b32 v1, 1, v0
  v_lshl_add_u32 v3, v1, 5, v97
  s_mov_b32 s9, 262144
L78_poll:
  buffer_load_dwordx4 v[48:51], v3, s[4:7], 0 offen sc1
  buffer_load_dwordx4 v[52:55], v3, s[4:7], 0 offen offset:16 sc1
  buffer_load_dword v56, v97, s[4:7], 0 offen offset:64 sc1
  s_waitcnt vmcnt(0)
  v_max3_u32 v1, v48, v49, v50
  v_max3_u32 v1, v1, v51, v52
  v_max3_u32 v1, v1, v53, v54
  v_max3_u32 v1, v1, v55, v56
  v_cmp_eq_u32 vcc, -1, v1
  s_nop 0
  s_cbranch_vccz L79_pdone
  s_mov_b64 exec, vcc
  s_sleep 16
  s_sub_u32 s9, s9, 1
  s_cbranch_scc0 L78_poll
L79_pdone:
  s_mov_b64 exec, -1
  v_cmp_ne_u32 vcc, s32, v56
  s_nop 0
  s_cmp_eq_u64 vcc, 0
  s_cselect_b32 s32, 2, 1
  v_mov_b32 v64, v48
  v_mov_b32 v66, v50
  v_mov_b32 v68, v52
  v_mov_b32 v70, v54
  v_max_f32_dpp v64, v64, v64 quad_perm:[2,3,0,1] row_mask:0xf bank_mask:0xf
  v_max_f32_dpp v66, v66, v66 quad_perm:[2,3,0,1] row_mask:0xf bank_mask:0xf
  v_max_f32_dpp v68, v68, v68 quad_perm:[2,3,0,1] row_mask:0xf bank_mask:0xf
  v_max_f32_dpp v70, v70, v70 quad_perm:[2,3,0,1] row_mask:0xf bank_mask:0xf
  v_max_f32_dpp v64, v64, v64 row_ror:4 row_mask:0xf bank_mask:0xf
  v_max_f32_dpp v66, v66, v66 row_ror:4 row_mask:0xf bank_mask:0xf
  v_max_f32_dpp v68, v68, v68 row_ror:4 row_mask:0xf bank_mask:0xf
  v_max_f32_dpp v70, v70, v70 row_ror:4 row_mask:0xf bank_mask:0xf
  v_max_f32_dpp v64, v64, v64 row_ror:8 row_mask:0xf bank_mask:0xf
  v_max_f32_dpp v66, v66, v66 row_ror:8 row_mask:0xf bank_mask:0xf
  v_max_f32_dpp v68, v68, v68 row_ror:8 row_mask:0xf bank_mask:0xf
  v_max_f32_dpp v70, v70, v70 row_ror:8 row_mask:0xf bank_mask:0xf
  v_mov_b32 v72, v64
  v_mov_b32 v73, v66
  v_mov_b32 v74, v68
  v_mov_b32 v75, v70
  v_permlane16_swap_b32 v64, v72
  v_permlane16_swap_b32 v66, v73
  v_permlane16_swap_b32 v68, v74
  v_permlane16_swap_b32 v70, v75
  v_max_f32 v64, v64, v72
  v_max_f32 v66, v66, v73
  v_max_f32 v68, v68, v74
  v_max_f32 v70, v70, v75
  v_mov_b32 v72, v64
  v_mov_b32 v73, v66
  v_mov_b32 v74, v68
  v_mov_b32 v75, v70
  v_permlane32_swap_b32 v64, v72
  v_permlane32_swap_b32 v66, v73
  v_permlane32_swap_b32 v68, v74
  v_permlane32_swap_b32 v70, v75
  v_max_f32 v64, v64, v72
  v_max_f32 v66, v66, v73
  v_max_f32 v68, v68, v74
  v_max_f32 v70, v70, v75
  v_sub_f32 v48, v48, v64
  v_mul_f32 v48, 0x3fb8aa3b, v48
  v_exp_f32 v48, v48
  s_nop 0
  v_mul_f32 v65, v48, v49
  v_sub_f32 v50, v50, v66
  v_mul_f32 v50, 0x3fb8aa3b, v50
  v_exp_f32 v50, v50
  s_nop 0
  v_mul_f32 v67, v50, v51
  v_sub_f32 v52, v52, v68
  v_mul_f32 v52, 0x3fb8aa3b, v52
  v_exp_f32 v52, v52
  s_nop 0
  v_mul_f32 v69, v52, v53
  v_sub_f32 v54, v54, v70
  v_mul_f32 v54, 0x3fb8aa3b, v54
  v_exp_f32 v54, v54
  s_nop 0
  v_mul_f32 v71, v54, v55
  v_add_f32_dpp v65, v65, v65 quad_perm:[2,3,0,1] row_mask:0xf bank_mask:0xf
  v_add_f32_dpp v67, v67, v67 quad_perm:[2,3,0,1] row_mask:0xf bank_mask:0xf
  v_add_f32_dpp v69, v69, v69 quad_perm:[2,3,0,1] row_mask:0xf bank_mask:0xf
  v_add_f32_dpp v71, v71, v71 quad_perm:[2,3,0,1] row_mask:0xf bank_mask:0xf
  v_add_f32_dpp v65, v65, v65 row_ror:4 row_mask:0xf bank_mask:0xf
  v_add_f32_dpp v67, v67, v67 row_ror:4 row_mask:0xf bank_mask:0xf
  v_add_f32_dpp v69, v69, v69 row_ror:4 row_mask:0xf bank_mask:0xf
  v_add_f32_dpp v71, v71, v71 row_ror:4 row_mask:0xf bank_mask:0xf
  v_add_f32_dpp v65, v65, v65 row_ror:8 row_mask:0xf bank_mask:0xf
  v_add_f32_dpp v67, v67, v67 row_ror:8 row_mask:0xf bank_mask:0xf
  v_add_f32_dpp v69, v69, v69 row_ror:8 row_mask:0xf bank_mask:0xf
  v_add_f32_dpp v71, v71, v71 row_ror:8 row_mask:0xf bank_mask:0xf
  v_mov_b32 v72, v65
  v_mov_b32 v73, v67
  v_mov_b32 v74, v69
  v_mov_b32 v75, v71
  v_permlane16_swap_b32 v65, v72
  v_permlane16_swap_b32 v67, v73
  v_permlane16_swap_b32 v69, v74
  v_permlane16_swap_b32 v71, v75
  v_add_f32 v65, v65, v72
  v_add_f32 v67, v67, v73
  v_add_f32 v69, v69, v74
  v_add_f32 v71, v71, v75
  v_mov_b32 v72, v65
  v_mov_b32 v73, v67
  v_mov_b32 v74, v69
  v_mov_b32 v75, v71
  v_permlane32_swap_b32 v65, v72
  v_permlane32_swap_b32 v67, v73
  v_permlane32_swap_b32 v69, v74
  v_permlane32_swap_b32 v71, v75
  v_add_f32 v65, v65, v72
  v_add_f32 v67, v67, v73
  v_add_f32 v69, v69, v74
  v_add_f32 v71, v71, v75
  v_lshlrev_b32 v1, 5, v0
  v_add_u32 v1, 154048, v1
  s_mov_b64 exec, 3
  ds_write_b128 v1, v[64:67]
  ds_write_b128 v1, v[68:71] offset:16
  s_mov_b64 exec, -1
  v_lshrrev_b32 v1, 2, v96
  v_lshlrev_b32 v1, 3, v1
  v_add_u32 v1, 154048, v1
  ds_read_b64 v[100:101], v1
  v_lshlrev_b32 v1, 2, v96
  v_add_u32 v1, 154112, v1
  v_mov_b32 v2, 153728
  v_mov_b32 v3, s32
  s_waitcnt lgkmcnt(0)
  v_sub_f32 v98, v98, v100
  v_mul_f32 v98, 0x3fb8aa3b, v98
  v_exp_f32 v98, v98
  v_rcp_f32 v101, v101
  s_nop 0
  v_mul_f32 v98, v98, v101
  ds_write_b32 v1, v98
  ds_write_b32 v2, v3 offset:40
  s_and_b32 s44, s2, 7
  s_lshr_b32 s8, s2, 3
  s_lshl_b32 s44, s44, 5
  s_add_u32 s44, s44, s8
  s_mul_i32 s44, s44, 384
  s_add_u32 s44, s44, 212992
  v_and_b32 v1, 0x31, v0
  v_bfe_u32 v2, v0, 2, 2
  v_lshl_add_u32 v1, v2, 1, v1
  v_bfe_u32 v2, v0, 1, 1
  v_lshl_add_u32 v1, v2, 3, v1
  v_lshl_add_u32 v102, v0, 3, s44
  v_min_u32 v1, 47, v1
  v_lshlrev_b32 v1, 4, v1
  v_add_u32 v103, 98304, v1
  s_add_u32 s12, s90, s44
  s_addc_u32 s13, s91, 0
  v_mov_b32 v104, 154112
  s_lshl_b32 s10, s34, 10
  s_lshl2_add_u32 s10, s35, s10
  s_add_u32 s10, s10, 73728
  v_mov_b32 v105, s10
  s_lshl_b32 s10, s34, 10
  s_add_u32 s10, s10, 74624
  v_min_u32 v1, 29, v0
  v_lshl_add_u32 v107, v1, 2, s10
  s_mov_b32 s34, 2
  s_mov_b32 s35, 688128
L_mitem:
  v_mov_b32 v1, 153728
  s_mov_b32 s9, 2097152
L80_lw:
  ds_read_b32 v2, v1 offset:36
  s_waitcnt lgkmcnt(0)
  v_readfirstlane_b32 s8, v2
  s_nop 0
  s_bitcmp1_b32 s8, s34
  s_cbranch_scc1 L81_lwd
  s_sleep 4
  s_sub_u32 s9, s9, 1
  s_cbranch_scc0 L80_lw
L81_lwd:
  s_mov_b32 s27, s35
  s_cmp_lg_u32 s32, 2
  s_cbranch_scc1 L_mown
  s_sub_u32 s10, s35, 196608
  s_cmp_gt_u32 s10, 196608
  s_cbranch_scc1 L_mown
  s_add_u32 s27, s35, 294912
  s_cmp_eq_u32 s35, 196608
  s_cbranch_scc1 L_mown
  s_cmp_eq_u32 s35, 393216
  s_cselect_b64 exec, 0x3ff, -1
  s_mov_b32 s9, 262144
L82_poll:
  buffer_load_dword v2, v107, s[4:7], 0 offen sc1
  s_waitcnt vmcnt(0)
  v_cmp_eq_u32 vcc, -1, v2
  s_nop 0
  s_cbranch_vccz L83_pdone
  s_mov_b64 exec, vcc
  s_sleep 16
  s_sub_u32 s9, s9, 1
  s_cbranch_scc0 L82_poll
L83_pdone:
  s_mov_b64 exec, -1
L_mown:
  ds_read_b128 v[108:111], v104
  ds_read_b128 v[48:51], v103 offset:0
  ds_read_b128 v[52:55], v103 offset:768
  ds_read_b128 v[56:59], v103 offset:12288
  ds_read_b128 v[60:63], v103 offset:13056
  ds_read_b128 v[64:67], v103 offset:24576
  ds_read_b128 v[68:71], v103 offset:25344
  ds_read_b128 v[72:75], v103 offset:36864
  ds_read_b128 v[76:79], v103 offset:37632
  s_waitcnt lgkmcnt(0)
  v_pk_add_f32 v[48:49], v[48:49], v[52:53]
  v_pk_add_f32 v[50:51], v[50:51], v[54:55]
  v_pk_mul_f32 v[48:49], v[48:49], v[108:109] op_sel_hi:[1,0]
  v_pk_mul_f32 v[50:51], v[50:51], v[108:109] op_sel_hi:[1,0]
  v_pk_add_f32 v[56:57], v[56:57], v[60:61]
  v_pk_add_f32 v[58:59], v[58:59], v[62:63]
  v_pk_fma_f32 v[48:49], v[56:57], v[108:109], v[48:49] op_sel:[0,1,0] op_sel_hi:[1,1,1]
  v_pk_fma_f32 v[50:51], v[58:59], v[108:109], v[50:51] op_sel:[0,1,0] op_sel_hi:[1,1,1]
  v_pk_add_f32 v[64:65], v[64:65], v[68:69]
  v_pk_add_f32 v[66:67], v[66:67], v[70:71]
  v_pk_fma_f32 v[48:49], v[64:65], v[110:111], v[48:49] op_sel_hi:[1,0,1]
  v_pk_fma_f32 v[50:51], v[66:67], v[110:111], v[50:51] op_sel_hi:[1,0,1]
  v_pk_add_f32 v[72:73], v[72:73], v[76:77]
  v_pk_add_f32 v[74:75], v[74:75], v[78:79]
  v_pk_fma_f32 v[48:49], v[72:73], v[110:111], v[48:49] op_sel:[0,1,0] op_sel_hi:[1,1,1]
  v_pk_fma_f32 v[50:51], v[74:75], v[110:111], v[50:51] op_sel:[0,1,0] op_sel_hi:[1,1,1]
  v_cvt_pk_bf16_f32 v2, v48, v49
  v_cvt_pk_bf16_f32 v3, v50, v51
  v_min_u32 v2, -2, v2
  v_min_u32 v3, -2, v3
  s_mov_b32 exec_hi, 0xffff
  s_cmp_lg_u32 s32, 2
  s_cbranch_scc1 L84_thru
  buffer_store_dwordx2 v[2:3], v102, s[4:7], s27 offen
  s_branch L85_stored
L84_thru:
  buffer_store_dwordx2 v[2:3], v102, s[4:7], s27 offen sc1
L85_stored:
  s_mov_b32 s6, 999424
  s_mov_b64 exec, 1
  s_waitcnt vmcnt(0) lgkmcnt(0)
  s_cmp_lg_u32 s32, 2
  s_cbranch_scc1 L86_thru
  buffer_store_dword v0, v105, s[4:7], 0 offen
  s_branch L87_stored
L86_thru:
  buffer_store_dword v0, v105, s[4:7], 0 offen sc1
L87_stored:
  s_mov_b64 exec, -1
  v_add_u32 v103, 1536, v103
  v_add_u32 v104, 16, v104
  v_add_u32 v105, 128, v105
  s_add_u32 s34, s34, 4
  s_sub_u32 s35, s35, 98304
  s_cmp_lg_u32 s35, 0
  s_cbranch_scc1 L_mitem
  s_cmp_eq_u32 s24, 3
  s_cbranch_scc1 L_back3
  s_cmp_eq_u32 s24, 4
  s_cbranch_scc1 L_back4
  s_cmp_eq_u32 s24, 5
  s_cbranch_scc1 L_back5
  s_endpgm
L_F:
  v_lshlrev_b32 v1, 2, v20
  s_lshl_b32 s41, s38, 7
  s_mul_i32 s14, s38, -96
  s_add_u32 s14, s14, 384
  v_lshrrev_b32 v2, 7, v21
  v_mad_u32_u24 v23, v2, s14, v21
  v_add_u32 v23, s41, v23
  s_mul_i32 s14, s14, 3072
  s_mov_b32 s15, 0
  v_sub_u32 v23, v23, v1
  v_mul_u32_u24 v1, 640, v22
  v_add_lshl_u32 v2, v1, v23, 1
  v_add_lshl_u32 v1, v1, v21, 1
  global_load_dwordx2 v[28:29], v2, s[64:65]
  global_load_dwordx2 v[30:31], v2, s[64:65] offset:32
  global_load_dwordx4 v[32:35], v1, s[64:65] offset:0
  global_load_dwordx4 v[36:39], v1, s[64:65] offset:320
  global_load_dwordx4 v[40:43], v1, s[64:65] offset:640
  global_load_dwordx4 v[44:47], v1, s[64:65] offset:960
  s_mul_i32 s10, s41, 3072
  s_lshl_b32 s11, s40, 6
  s_add_u32 s10, s10, s11
  v_mul_u32_u24 v1, 3072, v18
  v_and_b32 v2, 3, v19
  v_lshl_add_u32 v1, v2, 4, v1
  v_add_u32 v1, s10, v1
  v_add_u32 v2, 24576, v1
  v_mov_b32 v4, s76
  v_mov_b32 v5, s77
  v_mov_b32 v6, s78
  v_mov_b32 v7, s79
  v_cmp_gt_u32 vcc, 4, v19
  s_nop 1
  v_cndmask_b32 v10, v6, v4, vcc
  v_cndmask_b32 v11, v7, v5, vcc
  v_cndmask_b32 v12, v4, v6, vcc
  v_cndmask_b32 v13, v5, v7, vcc
  v_add_co_u32 v10, vcc, v10, v1
  s_nop 1
  v_addc_co_u32 v11, vcc, 0, v11, vcc
  v_add_co_u32 v12, vcc, v12, v2
  s_nop 1
  v_addc_co_u32 v13, vcc, 0, v13, vcc
  s_mov_b32 s10, 49152
  s_mov_b32 s11, 0
  s_add_u32 m0, s37, 0
  s_nop 0
  global_load_lds_dwordx4 v[10:11], off
  s_add_u32 m0, m0, 1024
  v_lshl_add_u64 v[10:11], v[10:11], 0, s[10:11]
  global_load_lds_dwordx4 v[12:13], off
  s_add_u32 m0, m0, 1024
  v_lshl_add_u64 v[12:13], v[12:13], 0, s[10:11]
  global_load_lds_dwordx4 v[10:11], off
  s_add_u32 m0, m0, 1024
  v_lshl_add_u64 v[10:11], v[10:11], 0, s[10:11]
  global_load_lds_dwordx4 v[12:13], off
  s_add_u32 m0, m0, 1024
  v_lshl_add_u64 v[12:13], v[12:13], 0, s[10:11]
  global_load_lds_dwordx4 v[10:11], off
  s_add_u32 m0, m0, 1024
  v_lshl_add_u64 v[10:11], v[10:11], 0, s[10:11]
  global_load_lds_dwordx4 v[12:13], off
  s_add_u32 m0, m0, 1024
  v_lshl_add_u64 v[12:13], v[12:13], 0, s[10:11]
  global_load_lds_dwordx4 v[10:11], off
  s_add_u32 m0, m0, 1024
  v_lshl_add_u64 v[10:11], v[10:11], 0, s[10:11]
  global_load_lds_dwordx4 v[12:13], off
  s_add_u32 m0, m0, 1024
  v_lshl_add_u64 v[12:13], v[12:13], 0, s[10:11]
  global_load_lds_dwordx4 v[10:11], off
  s_add_u32 m0, m0, 1024
  v_lshl_add_u64 v[10:11], v[10:11], 0, s[10:11]
  global_load_lds_dwordx4 v[12:13], off
  s_add_u32 m0, m0, 1024
  v_lshl_add_u64 v[12:13], v[12:13], 0, s[10:11]
  s_cmp_lg_u32 s39, 147456
  s_cbranch_scc1 L88_nb
  s_barrier
L88_nb:
  global_load_lds_dwordx4 v[10:11], off
  s_add_u32 m0, m0, 1024
  v_lshl_add_u64 v[10:11], v[10:11], 0, s[10:11]
  global_load_lds_dwordx4 v[12:13], off
  s_add_u32 m0, m0, 1024
  v_lshl_add_u64 v[12:13], v[12:13], 0, s[10:11]
  global_load_lds_dwordx4 v[10:11], off
  s_add_u32 m0, m0, 1024
  v_lshl_add_u64 v[10:11], v[10:11], 0, s[10:11]
  global_load_lds_dwordx4 v[12:13], off
  s_add_u32 m0, m0, 1024
  v_lshl_add_u64 v[12:13], v[12:13], 0, s[10:11]
  global_load_lds_dwordx4 v[10:11], off
  s_add_u32 m0, m0, 1024
  v_lshl_add_u64 v[10:11], v[10:11], 0, s[10:11]
  global_load_lds_dwordx4 v[12:13], off
  s_add_u32 m0, m0, 1024
  v_lshl_add_u64 v[12:13], v[12:13], 0, s[10:11]
  v_bfe_u32 v1, v0, 2, 2
  v_and_b32 v2, 3, v0
  v_lshl_add_u32 v3, v20, 2, v1
  v_lshrrev_b32 v4, 1, v1
  v_lshrrev_b32 v5, 1, v20
  v_lshl_add_u32 v4, v5, 1, v4
  v_lshlrev_b32 v3, 7, v3
  v_lshl_add_u32 v3, v2, 3, v3
  v_add_u32 v3, s37, v3
  v_xor_b32 v5, 0, v4
  v_lshl_add_u32 v14, v5, 5, v3
  v_xor_b32 v5, 1, v4
  v_lshl_add_u32 v15, v5, 5, v3
  v_xor_b32 v5, 2, v4
  v_lshl_add_u32 v16, v5, 5, v3
  v_xor_b32 v5, 3, v4
  v_lshl_add_u32 v17, v5, 5, v3
  s_lshl_b32 s10, s38, 9
  s_add_u32 s10, s10, s39
  v_lshlrev_b32 v1, 8, v22
  v_lshl_add_u32 v1, v20, 4, v1
  v_add_u32 v24, s10, v1
  v_lshl_add_u32 v25, v0, 3, s39
  s_lshr_b32 s10, s39, 9
  s_add_u32 s10, s10, 153444
  v_mov_b32 v26, s10
  v_mov_b32 v27, 1
  s_mov_b32 s45, 3
  s_waitcnt vmcnt(12)
  ds_read_b64_tr_b16 v[128:129], v14 offset:0
  ds_read_b64_tr_b16 v[130:131], v14 offset:2048
  ds_read_b64_tr_b16 v[132:133], v15 offset:0
  ds_read_b64_tr_b16 v[134:135], v15 offset:2048
  ds_read_b64_tr_b16 v[136:137], v16 offset:0
  ds_read_b64_tr_b16 v[138:139], v16 offset:2048
  ds_read_b64_tr_b16 v[140:141], v17 offset:0
  ds_read_b64_tr_b16 v[142:143], v17 offset:2048
  s_waitcnt vmcnt(8)
  ds_read_b64_tr_b16 v[144:145], v14 offset:4096
  ds_read_b64_tr_b16 v[146:147], v14 offset:6144
  ds_read_b64_tr_b16 v[148:149], v15 offset:4096
  ds_read_b64_tr_b16 v[150:151], v15 offset:6144
  ds_read_b64_tr_b16 v[152:153], v16 offset:4096
  ds_read_b64_tr_b16 v[154:155], v16 offset:6144
  ds_read_b64_tr_b16 v[156:157], v17 offset:4096
  ds_read_b64_tr_b16 v[158:159], v17 offset:6144
  s_waitcnt vmcnt(4)
  ds_read_b64_tr_b16 v[160:161], v14 offset:8192
  ds_read_b64_tr_b16 v[162:163], v14 offset:10240
  ds_read_b64_tr_b16 v[164:165], v15 offset:8192
  ds_read_b64_tr_b16 v[166:167], v15 offset:10240
  ds_read_b64_tr_b16 v[168:169], v16 offset:8192
  ds_read_b64_tr_b16 v[170:171], v16 offset:10240
  ds_read_b64_tr_b16 v[172:173], v17 offset:8192
  ds_read_b64_tr_b16 v[174:175], v17 offset:10240
  s_waitcnt vmcnt(0)
  ds_read_b64_tr_b16 v[176:177], v14 offset:12288
  ds_read_b64_tr_b16 v[178:179], v14 offset:14336
  ds_read_b64_tr_b16 v[180:181], v15 offset:12288
  ds_read_b64_tr_b16 v[182:183], v15 offset:14336
  ds_read_b64_tr_b16 v[184:185], v16 offset:12288
  ds_read_b64_tr_b16 v[186:187], v16 offset:14336
  ds_read_b64_tr_b16 v[188:189], v17 offset:12288
  ds_read_b64_tr_b16 v[190:191], v17 offset:14336
  s_waitcnt lgkmcnt(0)
  s_waitcnt vmcnt(0)
  v_and_b32 v49, 0xffff0000, v32
  v_lshlrev_b32 v48, 16, v32
  v_and_b32 v51, 0xffff0000, v33
  v_lshlrev_b32 v50, 16, v33
  v_and_b32 v53, 0xffff0000, v34
  v_lshlrev_b32 v52, 16, v34
  v_and_b32 v55, 0xffff0000, v35
  v_lshlrev_b32 v54, 16, v35
  v_and_b32 v57, 0xffff0000, v36
  v_lshlrev_b32 v56, 16, v36
  v_and_b32 v59, 0xffff0000, v37
  v_lshlrev_b32 v58, 16, v37
  v_and_b32 v61, 0xffff0000, v38
  v_lshlrev_b32 v60, 16, v38
  v_and_b32 v63, 0xffff0000, v39
  v_lshlrev_b32 v62, 16, v39
  v_and_b32 v65, 0xffff0000, v40
  v_lshlrev_b32 v64, 16, v40
  v_and_b32 v67, 0xffff0000, v41
  v_lshlrev_b32 v66, 16, v41
  v_and_b32 v69, 0xffff0000, v42
  v_lshlrev_b32 v68, 16, v42
  v_and_b32 v71, 0xffff0000, v43
  v_lshlrev_b32 v70, 16, v43
  v_and_b32 v73, 0xffff0000, v44
  v_lshlrev_b32 v72, 16, v44
  v_and_b32 v75, 0xffff0000, v45
  v_lshlrev_b32 v74, 16, v45
  v_and_b32 v77, 0xffff0000, v46
  v_lshlrev_b32 v76, 16, v46
  v_and_b32 v79, 0xffff0000, v47
  v_lshlrev_b32 v78, 16, v47
  v_and_b32 v225, 0xffff0000, v28
  v_lshlrev_b32 v224, 16, v28
  v_and_b32 v227, 0xffff0000, v29
  v_lshlrev_b32 v226, 16, v29
  v_and_b32 v229, 0xffff0000, v30
  v_lshlrev_b32 v228, 16, v30
  v_and_b32 v231, 0xffff0000, v31
  v_lshlrev_b32 v230, 16, v31
  v_pk_add_f32 v[80:81], v[48:49], v[64:65]
  v_pk_add_f32 v[82:83], v[50:51], v[66:67]
  v_pk_add_f32 v[84:85], v[52:53], v[68:69]
  v_pk_add_f32 v[86:87], v[54:55], v[70:71]
  v_pk_add_f32 v[88:89], v[56:57], v[72:73]
  v_pk_add_f32 v[90:91], v[58:59], v[74:75]
  v_pk_add_f32 v[92:93], v[60:61], v[76:77]
  v_pk_add_f32 v[94:95], v[62:63], v[78:79]
  v_pk_add_f32 v[80:81], v[80:81], v[88:89]
  v_pk_add_f32 v[82:83], v[82:83], v[90:91]
  v_pk_add_f32 v[84:85], v[84:85], v[92:93]
  v_pk_add_f32 v[86:87], v[86:87], v[94:95]
  v_pk_add_f32 v[80:81], v[80:81], v[84:85]
  v_pk_add_f32 v[82:83], v[82:83], v[86:87]
  v_pk_add_f32 v[80:81], v[80:81], v[82:83]
  v_add_f32 v6, v80, v81
  v_cndmask_b32 v6, 0, v6, s[16:17]
  s_nop 1
  v_add_f32_dpp v6, v6, v6 quad_perm:[2,3,0,1] row_mask:0xf bank_mask:0xf
  s_nop 1
  v_add_f32_dpp v6, v6, v6 row_ror:4 row_mask:0xf bank_mask:0xf
  s_nop 1
  v_add_f32_dpp v6, v6, v6 row_ror:8 row_mask:0xf bank_mask:0xf
  v_mov_b32 v1, v6
  s_nop 1
  v_permlane16_swap_b32 v6, v1
  v_add_f32 v6, v6, v1
  v_mov_b32 v1, v6
  s_nop 1
  v_permlane32_swap_b32 v6, v1
  v_add_f32 v6, v6, v1
  v_mul_f32 v248, 0x3acccccd, v6
  s_nop 0
  v_readlane_b32 s10, v248, 0
  v_readlane_b32 s11, v248, 1
  s_mov_b32 s18, 0
  s_mov_b32 s19, -1
  v_mov_b32 v1, s10
  v_mov_b32 v2, s11
  v_cndmask_b32 v250, v1, v2, s[18:19]
  s_cmp_lg_u32 s38, 0
  s_cbranch_scc1 L89_noprobe
  s_lshr_b32 s10, s2, 6
  s_lshl_b32 s10, s10, 14
  s_and_b32 s11, s2, 63
  s_lshl_b32 s11, s11, 7
  s_add_u32 s10, s10, s11
  s_add_u32 s10, s10, 999424
  s_add_u32 s10, s90, s10
  s_addc_u32 s11, s91, 0
  s_mov_b32 s12, -1
  s_mov_b32 s13, -1
  s_mov_b32 s9, 12
L90_probe:
  s_memtime s[32:33]
  s_waitcnt lgkmcnt(0)
  s_load_dword s8, s[10:11], 0 glc
  s_waitcnt lgkmcnt(0)
  s_memtime s[34:35]
  s_waitcnt lgkmcnt(0)
  s_sub_u32 s8, s34, s32
  s_min_u32 s12, s12, s8
  s_memtime s[32:33]
  s_waitcnt lgkmcnt(0)
  s_load_dword s8, s[10:11], 8192 glc
  s_waitcnt lgkmcnt(0)
  s_memtime s[34:35]
  s_waitcnt lgkmcnt(0)
  s_sub_u32 s8, s34, s32
  s_min_u32 s13, s13, s8
  s_sub_u32 s9, s9, 1
  s_cmp_lg_u32 s9, 0
  s_cbranch_scc1 L90_probe
  s_cmp_lt_u32 s13, s12
  s_cselect_b32 s8, 8192, 0
  v_mov_b32 v1, 153744
  v_mov_b32 v2, s8
  ds_write_b32 v1, v2
L89_noprobe:
  s_setprio 0
  v_mov_b32 v1, 153752
  s_mov_b32 s9, 2097152
L91_wake:
  ds_read_b64 v[2:3], v1
  s_waitcnt lgkmcnt(0)
  v_cmp_gt_u32 vcc, 1, v3
  s_nop 0
  s_cbranch_vccz L92_awake
  s_sleep 16
  s_sub_u32 s9, s9, 1
  s_cbranch_scc0 L91_wake
L92_awake:
  v_and_b32 v8, 7, v0
  v_cmp_gt_u32 vcc, 32, v0
  s_nop 1
  v_cndmask_b32 v8, v0, v8, vcc
  v_lshlrev_b32 v8, 2, v8
  s_mov_b32 s9, 262144
L93_flag:
  global_load_dword v9, v8, s[88:89] sc1
  s_waitcnt vmcnt(0)
  v_cmp_eq_u32 vcc, 0, v9
  s_nop 0
  s_cbranch_vccz L94_fdone
  s_sleep 8
  s_sub_u32 s9, s9, 1
  s_cbranch_scc0 L93_flag
L94_fdone:
  v_lshrrev_b32 v1, 6, v23
  v_lshl_add_u32 v1, v1, 1, v22
  v_lshlrev_b32 v1, 6, v1
  v_and_b32 v2, 63, v23
  v_add_lshl_u32 v8, v1, v2, 1
  v_add_u32 v8, 5120, v8
  v_add_u32 v9, 5120, v8
  s_mov_b32 s9, 262144
L95_poll:
  buffer_load_dwordx2 v[40:41], v8, s[4:7], 0 offen offset:0 sc1
  buffer_load_dwordx2 v[44:45], v8, s[4:7], 0 offen offset:2560 sc1
  buffer_load_dwordx2 v[48:49], v9, s[4:7], 0 offen offset:0 sc1
  buffer_load_dwordx2 v[42:43], v8, s[4:7], 0 offen offset:32 sc1
  buffer_load_dwordx2 v[46:47], v8, s[4:7], 0 offen offset:2592 sc1
  buffer_load_dwordx2 v[50:51], v9, s[4:7], 0 offen offset:32 sc1
  s_waitcnt vmcnt(0)
  v_max3_u32 v1, v40, v41, v42
  v_max3_u32 v1, v1, v43, v44
  v_max3_u32 v1, v1, v45, v46
  v_max3_u32 v1, v1, v47, v48
  v_max3_u32 v1, v1, v49, v50
  v_max_u32 v1, v1, v51
  v_cmp_eq_u32 vcc, -1, v1
  s_nop 0
  s_cbranch_vccz L96_pdone
  s_sleep 32
  s_sub_u32 s9, s9, 1
  s_cbranch_scc0 L95_poll
L96_pdone:
  v_and_b32 v233, 0xffff0000, v40
  v_lshlrev_b32 v232, 16, v40
  v_and_b32 v235, 0xffff0000, v41
  v_lshlrev_b32 v234, 16, v41
  v_and_b32 v237, 0xffff0000, v42
  v_lshlrev_b32 v236, 16, v42
  v_and_b32 v239, 0xffff0000, v43
  v_lshlrev_b32 v238, 16, v43
  v_and_b32 v241, 0xffff0000, v48
  v_lshlrev_b32 v240, 16, v48
  v_and_b32 v243, 0xffff0000, v49
  v_lshlrev_b32 v242, 16, v49
  v_and_b32 v245, 0xffff0000, v50
  v_lshlrev_b32 v244, 16, v50
  v_and_b32 v247, 0xffff0000, v51
  v_lshlrev_b32 v246, 16, v51
  v_pk_add_f32 v[240:241], v[240:241], 1.0 op_sel_hi:[1,0]
  v_pk_add_f32 v[242:243], v[242:243], 1.0 op_sel_hi:[1,0]
  v_pk_add_f32 v[244:245], v[244:245], 1.0 op_sel_hi:[1,0]
  v_pk_add_f32 v[246:247], v[246:247], 1.0 op_sel_hi:[1,0]
  v_cvt_pk_bf16_f32 v80, v240, v241
  v_cvt_pk_bf16_f32 v81, v242, v243
  v_cvt_pk_bf16_f32 v82, v244, v245
  v_cvt_pk_bf16_f32 v83, v246, v247
  v_and_b32 v241, 0xffff0000, v80
  v_lshlrev_b32 v240, 16, v80
  v_and_b32 v243, 0xffff0000, v81
  v_lshlrev_b32 v242, 16, v81
  v_and_b32 v245, 0xffff0000, v82
  v_lshlrev_b32 v244, 16, v82
  v_and_b32 v247, 0xffff0000, v83
  v_lshlrev_b32 v246, 16, v83
  v_pk_add_f32 v[224:225], v[224:225], v[248:249] op_sel_hi:[1,0] neg_lo:[0,1] neg_hi:[0,1]
  v_pk_add_f32 v[226:227], v[226:227], v[248:249] op_sel_hi:[1,0] neg_lo:[0,1] neg_hi:[0,1]
  v_pk_add_f32 v[228:229], v[228:229], v[248:249] op_sel_hi:[1,0] neg_lo:[0,1] neg_hi:[0,1]
  v_pk_add_f32 v[230:231], v[230:231], v[248:249] op_sel_hi:[1,0] neg_lo:[0,1] neg_hi:[0,1]
  v_pk_mul_f32 v[120:121], v[224:225], v[240:241]
  v_pk_mul_f32 v[122:123], v[226:227], v[242:243]
  v_pk_mul_f32 v[124:125], v[228:229], v[244:245]
  v_pk_mul_f32 v[126:127], v[230:231], v[246:247]
  v_pk_mul_f32 v[240:241], v[240:241], v[232:233]
  v_pk_mul_f32 v[242:243], v[242:243], v[234:235]
  v_pk_mul_f32 v[244:245], v[244:245], v[236:237]
  v_pk_mul_f32 v[246:247], v[246:247], v[238:239]
  v_mov_b32 v84, v44
  v_mov_b32 v85, v45
  v_mov_b32 v86, v46
  v_mov_b32 v87, v47
  v_lshrrev_b32 v1, 6, v23
  v_lshlrev_b32 v1, 8, v1
  v_and_b32 v2, 32, v23
  v_lshl_add_u32 v2, v22, 4, v2
  v_add_u32 v1, 147456, v1
  v_add_u32 v208, v1, v2
  v_lshrrev_b32 v1, 1, v20
  v_lshl_add_u32 v208, v1, 14, v208
  v_and_b32 v1, 1, v20
  v_mul_u32_u24 v1, 2560, v1
  v_add_u32 v208, v1, v208
  v_lshlrev_b32 v1, 4, v22
  v_mov_b32 v2, 0x3f80
  v_lshlrev_b32 v1, v1, v2
  v_bfe_u32 v2, v0, 1, 3
  v_cmp_eq_u32 vcc, 0, v2
  s_nop 1
  v_cndmask_b32 v88, 0, v1, vcc
  v_cmp_eq_u32 vcc, 1, v2
  s_nop 1
  v_cndmask_b32 v89, 0, v1, vcc
  v_cmp_eq_u32 vcc, 2, v2
  s_nop 1
  v_cndmask_b32 v90, 0, v1, vcc
  v_cmp_eq_u32 vcc, 3, v2
  s_nop 1
  v_cndmask_b32 v91, 0, v1, vcc
  v_cmp_eq_u32 vcc, 4, v2
  s_nop 1
  v_cndmask_b32 v92, 0, v1, vcc
  v_cmp_eq_u32 vcc, 5, v2
  s_nop 1
  v_cndmask_b32 v93, 0, v1, vcc
  v_cmp_eq_u32 vcc, 6, v2
  s_nop 1
  v_cndmask_b32 v94, 0, v1, vcc
  v_cmp_eq_u32 vcc, 7, v2
  s_nop 1
  v_cndmask_b32 v95, 0, v1, vcc
  v_lshrrev_b32 v1, 6, v23
  v_lshl_add_u32 v1, v1, 1, v22
  v_lshlrev_b32 v1, 6, v1
  v_and_b32 v2, 63, v23
  v_add_lshl_u32 v209, v1, v2, 1
  v_add_u32 v209, 114688, v209
  v_lshrrev_b32 v1, 5, v0
  v_lshl_add_u32 v2, v22, 3, v1
  v_lshlrev_b32 v2, 2, v2
  s_lshl3_add_u32 s10, s38, 153600
  v_add_u32 v210, s10, v2
  v_lshlrev_b32 v2, 5, v1
  v_add_u32 v211, 153600, v2
  v_and_b32 v2, 31, v0
  v_lshlrev_b32 v3, 8, v1
  v_lshl_add_u32 v3, v2, 2, v3
  v_add_u32 v25, s39, v3
  v_add_u32 v213, 1024, v25
  s_lshl_b32 s10, s40, 7
  s_add_u32 s10, s10, 131072
  v_lshrrev_b32 v3, 3, v2
  v_lshl_add_u32 v3, v3, 1, v1
  v_and_b32 v2, 7, v2
  v_lshl_add_u32 v3, v3, 3, v2
  v_lshl_add_u32 v212, v3, 1, s10
  s_mov_b32 s46, 8192
  s_mov_b32 s6, 0
  s_mov_b32 s30, 0
  s_mov_b32 s45, 0
  v_mov_b32 v27, 0
L_Ft:
  v_mov_b32 v1, 153744
  ds_read_b32 v1, v1
  s_waitcnt lgkmcnt(0)
  v_readfirstlane_b32 s47, v1
  s_nop 0
  s_and_b32 s47, s47, 8192
  s_add_u32 s20, s47, 32768
  v_add_u32 v2, 2048, v25
  v_add_u32 v3, 2048, v213
  ds_read2_b32 v[96:97], v2 offset0:0 offset1:32
  ds_read2_b32 v[98:99], v2 offset0:128 offset1:160
  ds_read2_b32 v[100:101], v3 offset0:0 offset1:32
  ds_read2_b32 v[102:103], v3 offset0:128 offset1:160
  s_waitcnt lgkmcnt(0)
  v_pk_add_f32 v[96:97], v[96:97], v[100:101]
  v_pk_add_f32 v[98:99], v[98:99], v[102:103]
  v_pk_add_f32 v[214:215], v[96:97], v[98:99]
  v_add_u32 v2, 4096, v25
  v_add_u32 v3, 4096, v213
  ds_read2_b32 v[96:97], v2 offset0:0 offset1:32
  ds_read2_b32 v[98:99], v2 offset0:128 offset1:160
  ds_read2_b32 v[100:101], v3 offset0:0 offset1:32
  ds_read2_b32 v[102:103], v3 offset0:128 offset1:160
  s_waitcnt lgkmcnt(0)
  v_pk_add_f32 v[96:97], v[96:97], v[100:101]
  v_pk_add_f32 v[98:99], v[98:99], v[102:103]
  v_pk_add_f32 v[216:217], v[96:97], v[98:99]
  s_mov_b32 s9, 262144
  s_mov_b64 vcc, s[16:17]
L97_spoll:
  s_sub_u32 s9, s9, 1
  s_cbranch_scc1 L98_sdone
  s_mov_b64 exec, vcc
  buffer_load_dwordx4 v[48:51], v208, s[4:7], s47 offen offset:0 sc1
  buffer_load_dwordx4 v[56:59], v208, s[4:7], s47 offen offset:128 sc1
  buffer_load_dwordx4 v[52:55], v208, s[4:7], s47 offen offset:64 sc1
  buffer_load_dwordx4 v[60:63], v208, s[4:7], s47 offen offset:192 sc1
  buffer_load_dwordx4 v[64:67], v208, s[4:7], s20 offen offset:0 sc1
  buffer_load_dwordx4 v[72:75], v208, s[4:7], s20 offen offset:128 sc1
  buffer_load_dwordx4 v[68:71], v208, s[4:7], s20 offen offset:64 sc1
  buffer_load_dwordx4 v[76:79], v208, s[4:7], s20 offen offset:192 sc1
  s_mov_b64 exec, -1
  s_waitcnt vmcnt(7)
  v_mfma_f32_16x16x32_bf16 v[32:35], v[88:91], v[48:51], 0
  v_max3_u32 v1, v48, v49, v50
  v_max_u32 v1, v1, v51
  s_waitcnt vmcnt(6)
  v_mfma_f32_16x16x32_bf16 v[36:39], v[88:91], v[56:59], 0
  v_max3_u32 v1, v1, v56, v57
  v_max3_u32 v1, v1, v58, v59
  s_waitcnt vmcnt(5)
  v_mfma_f32_16x16x32_bf16 v[32:35], v[92:95], v[52:55], v[32:35]
  v_max3_u32 v1, v1, v52, v53
  v_max3_u32 v1, v1, v54, v55
  s_waitcnt vmcnt(4)
  v_mfma_f32_16x16x32_bf16 v[36:39], v[92:95], v[60:63], v[36:39]
  v_max3_u32 v1, v1, v60, v61
  v_max3_u32 v1, v1, v62, v63
  s_waitcnt vmcnt(3)
  v_mfma_f32_16x16x32_bf16 v[32:35], v[88:91], v[64:67], v[32:35]
  v_max3_u32 v1, v1, v64, v65
  v_max3_u32 v1, v1, v66, v67
  s_waitcnt vmcnt(2)
  v_mfma_f32_16x16x32_bf16 v[36:39], v[88:91], v[72:75], v[36:39]
  v_max3_u32 v1, v1, v72, v73
  v_max3_u32 v1, v1, v74, v75
  s_waitcnt vmcnt(1)
  v_mfma_f32_16x16x32_bf16 v[32:35], v[92:95], v[68:71], v[32:35]
  v_max3_u32 v1, v1, v68, v69
  v_max3_u32 v1, v1, v70, v71
  s_waitcnt vmcnt(0)
  v_mfma_f32_16x16x32_bf16 v[36:39], v[92:95], v[76:79], v[36:39]
  v_max3_u32 v1, v1, v76, v77
  v_max3_u32 v1, v1, v78, v79
  v_cmp_eq_u32 vcc, -1, v1
  s_nop 0
  s_and_b64 vcc, vcc, s[16:17]
  s_cbranch_vccnz L97_spoll
L98_sdone:
  v_pk_fma_f32 v[40:41], v[32:33], v[240:241], v[120:121]
  v_pk_fma_f32 v[42:43], v[34:35], v[242:243], v[122:123]
  v_pk_fma_f32 v[44:45], v[36:37], v[244:245], v[124:125]
  v_pk_fma_f32 v[46:47], v[38:39], v[246:247], v[126:127]
  v_cvt_pk_bf16_f32 v28, v40, v41
  v_cvt_pk_bf16_f32 v29, v42, v43
  v_cvt_pk_bf16_f32 v30, v44, v45
  v_cvt_pk_bf16_f32 v31, v46, v47
  s_nop 1
  v_mfma_f32_16x16x32_bf16 v[96:99], v[128:131], v[28:31], 0
  v_mov_b32_dpp v116, v28 row_shl:2 row_mask:0xf bank_mask:0xf
  v_mov_b32_dpp v117, v29 row_shl:2 row_mask:0xf bank_mask:0xf
  v_mfma_f32_16x16x32_bf16 v[100:103], v[132:135], v[28:31], 0
  v_mov_b32_dpp v118, v30 row_shl:2 row_mask:0xf bank_mask:0xf
  v_mov_b32_dpp v119, v31 row_shl:2 row_mask:0xf bank_mask:0xf
  v_mfma_f32_16x16x32_bf16 v[104:107], v[136:139], v[28:31], 0
  v_fma_f32 v32, v32, v232, v224
  v_mul_f32 v56, v32, v32
  v_fma_f32 v33, v33, v233, v225
  v_mfma_f32_16x16x32_bf16 v[108:111], v[140:143], v[28:31], 0
  v_fmac_f32 v56, v33, v33
  v_add_f32 v58, v33, v32
  v_fma_f32 v34, v34, v234, v226
  v_mfma_f32_16x16x32_bf16 v[96:99], v[144:147], v[116:119], v[96:99]
  v_mov_b32_dpp v112, v28 row_shl:4 row_mask:0xf bank_mask:0xf
  v_mov_b32_dpp v113, v29 row_shl:4 row_mask:0xf bank_mask:0xf
  v_mfma_f32_16x16x32_bf16 v[100:103], v[148:151], v[116:119], v[100:103]
  v_mov_b32_dpp v114, v30 row_shl:4 row_mask:0xf bank_mask:0xf
  v_mov_b32_dpp v115, v31 row_shl:4 row_mask:0xf bank_mask:0xf
  v_mfma_f32_16x16x32_bf16 v[104:107], v[152:155], v[116:119], v[104:107]
  v_fmac_f32 v56, v34, v34
  v_add_f32 v58, v34, v58
  v_fma_f32 v35, v35, v235, v227
  v_mfma_f32_16x16x32_bf16 v[108:111], v[156:159], v[116:119], v[108:111]
  v_fmac_f32 v56, v35, v35
  v_add_f32 v58, v35, v58
  v_fma_f32 v36, v36, v236, v228
  v_mfma_f32_16x16x32_bf16 v[96:99], v[160:163], v[112:115], v[96:99]
  v_mov_b32_dpp v116, v28 row_shl:6 row_mask:0xf bank_mask:0xf
  v_mov_b32_dpp v117, v29 row_shl:6 row_mask:0xf bank_mask:0xf
  v_mfma_f32_16x16x32_bf16 v[100:103], v[164:167], v[112:115], v[100:103]
  v_mov_b32_dpp v118, v30 row_shl:6 row_mask:0xf bank_mask:0xf
  v_mov_b32_dpp v119, v31 row_shl:6 row_mask:0xf bank_mask:0xf
  v_mfma_f32_16x16x32_bf16 v[104:107], v[168:171], v[112:115], v[104:107]
  v_fmac_f32 v56, v36, v36
  v_add_f32 v58, v36, v58
  v_fma_f32 v37, v37, v237, v229
  v_mfma_f32_16x16x32_bf16 v[108:111], v[172:175], v[112:115], v[108:111]
  v_fmac_f32 v56, v37, v37
  v_add_f32 v58, v37, v58
  v_fma_f32 v38, v38, v238, v230
  v_mfma_f32_16x16x32_bf16 v[96:99], v[176:179], v[116:119], v[96:99]
  v_mov_b32_dpp v112, v28 row_shl:8 row_mask:0xf bank_mask:0xf
  v_mov_b32_dpp v113, v29 row_shl:8 row_mask:0xf bank_mask:0xf
  v_mfma_f32_16x16x32_bf16 v[100:103], v[180:183], v[116:119], v[100:103]
  v_mov_b32_dpp v114, v30 row_shl:8 row_mask:0xf bank_mask:0xf
  v_mov_b32_dpp v115, v31 row_shl:8 row_mask:0xf bank_mask:0xf
  v_mfma_f32_16x16x32_bf16 v[104:107], v[184:187], v[116:119], v[104:107]
  v_fmac_f32 v56, v38, v38
  v_add_f32 v58, v38, v58
  v_fma_f32 v39, v39, v239, v231
  v_mfma_f32_16x16x32_bf16 v[108:111], v[188:191], v[116:119], v[108:111]
  v_fmac_f32 v56, v39, v39
  v_add_f32 v58, v39, v58
  s_nop 0
  v_mfma_f32_16x16x32_bf16 v[96:99], v[192:195], v[112:115], v[96:99]
  v_permlane32_swap_b32 v58, v56
  v_add_f32 v56, v56, v58
  v_cndmask_b32 v56, 0, v56, s[16:17]
  v_mfma_f32_16x16x32_bf16 v[100:103], v[196:199], v[112:115], v[100:103]
  s_nop 0
  v_add_f32_dpp v56, v56, v56 quad_perm:[2,3,0,1] row_mask:0xf bank_mask:0xf
  v_mfma_f32_16x16x32_bf16 v[104:107], v[200:203], v[112:115], v[104:107]
  s_nop 0
  v_add_f32_dpp v56, v56, v56 row_ror:4 row_mask:0xf bank_mask:0xf
  v_mfma_f32_16x16x32_bf16 v[108:111], v[204:207], v[112:115], v[108:111]
  s_nop 0
  v_add_f32_dpp v56, v56, v56 row_ror:8 row_mask:0xf bank_mask:0xf
  v_mov_b32 v57, v56
  s_nop 1
  v_permlane16_swap_b32 v56, v57
  v_add_f32 v56, v56, v57
  s_mov_b32 exec_lo, 0x00030003
  s_mov_b32 exec_hi, 0x00030003
  ds_write_b128 v24, v[96:99] offset:0
  ds_write_b128 v24, v[100:103] offset:64
  ds_write_b128 v24, v[104:107] offset:128
  ds_write_b128 v24, v[108:111] offset:192
  ds_write_b32 v210, v56
  s_mov_b64 exec, 1
  ds_add_rtn_u32 v1, v26, v27
  s_mov_b64 exec, -1
  ds_read_b128 v[56:59], v211
  ds_read_b128 v[60:63], v211 offset:16
  ds_read2_b32 v[64:65], v25 offset0:0 offset1:32
  ds_read2_b32 v[66:67], v25 offset0:128 offset1:160
  ds_read2_b32 v[68:69], v213 offset0:0 offset1:32
  ds_read2_b32 v[70:71], v213 offset0:128 offset1:160
  s_cmp_lg_u32 s40, 0
  s_cbranch_scc1 L_Fnox
  v_pk_add_f32 v[40:41], v[32:33], v[248:249] op_sel_hi:[1,0]
  v_pk_add_f32 v[42:43], v[34:35], v[248:249] op_sel_hi:[1,0]
  v_pk_add_f32 v[44:45], v[36:37], v[248:249] op_sel_hi:[1,0]
  v_pk_add_f32 v[46:47], v[38:39], v[248:249] op_sel_hi:[1,0]
  v_cvt_pk_bf16_f32 v48, v40, v41
  v_cvt_pk_bf16_f32 v49, v42, v43
  v_cvt_pk_bf16_f32 v50, v44, v45
  v_cvt_pk_bf16_f32 v51, v46, v47
  v_min_u32 v48, -2, v48
  v_min_u32 v49, -2, v49
  v_min_u32 v50, -2, v50
  v_min_u32 v51, -2, v51
  s_mov_b64 exec, s[16:17]
  buffer_store_dwordx2 v[48:49], v209, s[4:7], 0 offen sc1
  buffer_store_dwordx2 v[50:51], v209, s[4:7], 0 offen offset:32 sc1
  buffer_store_dwordx2 v[48:49], v209, s[4:7], s46 offen sc1
  buffer_store_dwordx2 v[50:51], v209, s[4:7], s46 offen offset:32 sc1
  s_mov_b64 exec, -1
L_Fnox:
  s_waitcnt lgkmcnt(4)
  v_readfirstlane_b32 s8, v1
  v_pk_add_f32 v[56:57], v[56:57], v[58:59]
  v_pk_add_f32 v[60:61], v[60:61], v[62:63]
  v_pk_add_f32 v[56:57], v[56:57], v[60:61]
  v_mul_f32 v56, 0x3acccccd, v56
  v_mul_f32 v8, 0x3acccccd, v57
  v_add_f32 v6, v250, v56
  v_fma_f32 v8, -v56, v56, v8
  v_max_f32 v8, 0, v8
  v_cvt_pk_bf16_f32 v1, v6, v8
  v_and_b32 v8, 0xffff0000, v1
  v_add_f32 v8, 0x3727c5ac, v8
  v_cvt_pk_bf16_f32 v8, v8, v8
  v_lshlrev_b32 v8, 16, v8
  v_sqrt_f32 v8, v8
  v_lshlrev_b32 v6, 16, v1
  v_cvt_pk_bf16_f32 v8, v8, v8
  v_lshlrev_b32 v8, 16, v8
  v_rcp_f32 v8, v8
  v_sub_f32 v6, v250, v6
  s_waitcnt lgkmcnt(0)
  v_pk_add_f32 v[64:65], v[64:65], v[68:69]
  v_pk_add_f32 v[66:67], v[66:67], v[70:71]
  v_pk_add_f32 v[64:65], v[64:65], v[66:67]
  v_pk_fma_f32 v[96:97], v[214:215], v[6:7], v[64:65] op_sel_hi:[1,0,1]
  v_pk_fma_f32 v[96:97], v[96:97], v[8:9], v[216:217] op_sel_hi:[1,0,1]
  v_cvt_pk_bf16_f32 v98, v96, v97
  v_lshlrev_b32 v100, 16, v98
  v_mul_f32 v4, 0x3fb8aa3b, v100
  v_exp_f32 v4, -v4
  s_cmp_lg_u32 s8, s45
  s_cbranch_scc1 L_end
  v_and_b32 v101, 0xffff0000, v98
  v_add_f32 v4, 1.0, v4
  v_rcp_f32 v4, v4
  s_mov_b32 s10, 0x55555555
  v_mul_f32 v2, v100, v4
  v_cvt_pk_bf16_f32 v2, v2, v2
  v_lshlrev_b32 v2, 16, v2
  v_mul_f32 v2, v2, v101
  s_mov_b32 s11, 0x55555555
  s_nop 0
  v_mov_b32_dpp v3, v2 quad_perm:[1,0,3,2] row_mask:0xf bank_mask:0xf
  s_mov_b64 exec, s[10:11]
  v_cvt_pk_bf16_f32 v2, v2, v3
  v_min_u32 v2, -2, v2
  buffer_store_dword v2, v212, s[4:7], 0 offen sc1
  buffer_store_dword v2, v212, s[4:7], s46 offen sc1
  s_cmp_lg_u32 s45, 0
  s_cbranch_scc1 L99_real
  s_mov_b64 exec, -1
  s_mov_b32 s6, 999424
  s_mov_b32 s30, 2560
  s_mov_b32 s45, 3
  v_mov_b32 v27, 1
  s_waitcnt vmcnt(0)
  s_mov_b32 s24, 4
  s_cmp_eq_u32 s38, 3
  s_cbranch_scc1 L_merge
L_back4:
  v_mov_b32 v1, 153752
  v_mov_b32 v2, 1
  s_mov_b64 exec, 1
  ds_add_u32 v1, v2
  s_mov_b64 exec, -1
  s_mov_b32 s9, 2097152
L100_wake:
  ds_read_b64 v[2:3], v1
  s_waitcnt lgkmcnt(0)
  v_lshrrev_b32 v2, 2, v2
  v_mul_u32_u24 v3, v2, v3
  v_cmp_gt_u32 vcc, 64, v3
  s_nop 0
  s_cbranch_vccz L101_awake
  s_sleep 1
  s_sub_u32 s9, s9, 1
  s_cbranch_scc0 L100_wake
L101_awake:
  s_mov_b32 s10, 49152
  s_mov_b32 s11, 0
  s_add_u32 m0, s37, 16384
  v_lshl_add_u64 v[10:11], v[10:11], 0, s[14:15]
  global_load_lds_dwordx4 v[10:11], off
  s_add_u32 m0, m0, 1024
  v_lshl_add_u64 v[10:11], v[10:11], 0, s[10:11]
  v_lshl_add_u64 v[12:13], v[12:13], 0, s[14:15]
  global_load_lds_dwordx4 v[12:13], off
  s_add_u32 m0, m0, 1024
  v_lshl_add_u64 v[12:13], v[12:13], 0, s[10:11]
  global_load_lds_dwordx4 v[10:11], off
  s_add_u32 m0, m0, 1024
  v_lshl_add_u64 v[10:11], v[10:11], 0, s[10:11]
  global_load_lds_dwordx4 v[12:13], off
  s_add_u32 m0, m0, 1024
  v_lshl_add_u64 v[12:13], v[12:13], 0, s[10:11]
  s_waitcnt vmcnt(0)
  ds_read_b64_tr_b16 v[192:193], v14 offset:16384
  ds_read_b64_tr_b16 v[194:195], v14 offset:18432
  ds_read_b64_tr_b16 v[196:197], v15 offset:16384
  ds_read_b64_tr_b16 v[198:199], v15 offset:18432
  ds_read_b64_tr_b16 v[200:201], v16 offset:16384
  ds_read_b64_tr_b16 v[202:203], v16 offset:18432
  ds_read_b64_tr_b16 v[204:205], v17 offset:16384
  ds_read_b64_tr_b16 v[206:207], v17 offset:18432
  s_waitcnt lgkmcnt(0)
  v_mfma_f32_16x16x32_bf16 v[96:99], v[128:131], v[80:83], 0
  v_mov_b32_dpp v116, v80 row_shl:2 row_mask:0xf bank_mask:0xf
  v_mov_b32_dpp v117, v81 row_shl:2 row_mask:0xf bank_mask:0xf
  v_mfma_f32_16x16x32_bf16 v[100:103], v[132:135], v[80:83], 0
  v_mov_b32_dpp v118, v82 row_shl:2 row_mask:0xf bank_mask:0xf
  v_mov_b32_dpp v119, v83 row_shl:2 row_mask:0xf bank_mask:0xf
  v_mfma_f32_16x16x32_bf16 v[104:107], v[136:139], v[80:83], 0
  v_mfma_f32_16x16x32_bf16 v[108:111], v[140:143], v[80:83], 0
  v_mfma_f32_16x16x32_bf16 v[96:99], v[144:147], v[116:119], v[96:99]
  v_mov_b32_dpp v112, v80 row_shl:4 row_mask:0xf bank_mask:0xf
  v_mov_b32_dpp v113, v81 row_shl:4 row_mask:0xf bank_mask:0xf
  v_mfma_f32_16x16x32_bf16 v[100:103], v[148:151], v[116:119], v[100:103]
  v_mov_b32_dpp v114, v82 row_shl:4 row_mask:0xf bank_mask:0xf
  v_mov_b32_dpp v115, v83 row_shl:4 row_mask:0xf bank_mask:0xf
  v_mfma_f32_16x16x32_bf16 v[104:107], v[152:155], v[116:119], v[104:107]
  v_mfma_f32_16x16x32_bf16 v[108:111], v[156:159], v[116:119], v[108:111]
  v_mfma_f32_16x16x32_bf16 v[96:99], v[160:163], v[112:115], v[96:99]
  v_mov_b32_dpp v116, v80 row_shl:6 row_mask:0xf bank_mask:0xf
  v_mov_b32_dpp v117, v81 row_shl:6 row_mask:0xf bank_mask:0xf
  v_mfma_f32_16x16x32_bf16 v[100:103], v[164:167], v[112:115], v[100:103]
  v_mov_b32_dpp v118, v82 row_shl:6 row_mask:0xf bank_mask:0xf
  v_mov_b32_dpp v119, v83 row_shl:6 row_mask:0xf bank_mask:0xf
  v_mfma_f32_16x16x32_bf16 v[104:107], v[168:171], v[112:115], v[104:107]
  v_mfma_f32_16x16x32_bf16 v[108:111], v[172:175], v[112:115], v[108:111]
  v_mfma_f32_16x16x32_bf16 v[96:99], v[176:179], v[116:119], v[96:99]
  v_mov_b32_dpp v112, v80 row_shl:8 row_mask:0xf bank_mask:0xf
  v_mov_b32_dpp v113, v81 row_shl:8 row_mask:0xf bank_mask:0xf
  v_mfma_f32_16x16x32_bf16 v[100:103], v[180:183], v[116:119], v[100:103]
  v_mov_b32_dpp v114, v82 row_shl:8 row_mask:0xf bank_mask:0xf
  v_mov_b32_dpp v115, v83 row_shl:8 row_mask:0xf bank_mask:0xf
  v_mfma_f32_16x16x32_bf16 v[104:107], v[184:187], v[116:119], v[104:107]
  v_mfma_f32_16x16x32_bf16 v[108:111], v[188:191], v[116:119], v[108:111]
  v_mfma_f32_16x16x32_bf16 v[96:99], v[192:195], v[112:115], v[96:99]
  v_mfma_f32_16x16x32_bf16 v[100:103], v[196:199], v[112:115], v[100:103]
  v_mfma_f32_16x16x32_bf16 v[104:107], v[200:203], v[112:115], v[104:107]
  v_mfma_f32_16x16x32_bf16 v[108:111], v[204:207], v[112:115], v[108:111]
  s_mov_b32 exec_lo, 0x00030003
  s_mov_b32 exec_hi, 0x00030003
  s_nop 2
  ds_write_b128 v24, v[96:99] offset:2048
  ds_write_b128 v24, v[100:103] offset:2112
  ds_write_b128 v24, v[104:107] offset:2176
  ds_write_b128 v24, v[108:111] offset:2240
  s_mov_b64 exec, -1
  s_waitcnt lgkmcnt(0)
  v_mfma_f32_16x16x32_bf16 v[96:99], v[128:131], v[84:87], 0
  v_mov_b32_dpp v116, v84 row_shl:2 row_mask:0xf bank_mask:0xf
  v_mov_b32_dpp v117, v85 row_shl:2 row_mask:0xf bank_mask:0xf
  v_mfma_f32_16x16x32_bf16 v[100:103], v[132:135], v[84:87], 0
  v_mov_b32_dpp v118, v86 row_shl:2 row_mask:0xf bank_mask:0xf
  v_mov_b32_dpp v119, v87 row_shl:2 row_mask:0xf bank_mask:0xf
  v_mfma_f32_16x16x32_bf16 v[104:107], v[136:139], v[84:87], 0
  v_mfma_f32_16x16x32_bf16 v[108:111], v[140:143], v[84:87], 0
  v_mfma_f32_16x16x32_bf16 v[96:99], v[144:147], v[116:119], v[96:99]
  v_mov_b32_dpp v112, v84 row_shl:4 row_mask:0xf bank_mask:0xf
  v_mov_b32_dpp v113, v85 row_shl:4 row_mask:0xf bank_mask:0xf
  v_mfma_f32_16x16x32_bf16 v[100:103], v[148:151], v[116:119], v[100:103]
  v_mov_b32_dpp v114, v86 row_shl:4 row_mask:0xf bank_mask:0xf
  v_mov_b32_dpp v115, v87 row_shl:4 row_mask:0xf bank_mask:0xf
  v_mfma_f32_16x16x32_bf16 v[104:107], v[152:155], v[116:119], v[104:107]
  v_mfma_f32_16x16x32_bf16 v[108:111], v[156:159], v[116:119], v[108:111]
  v_mfma_f32_16x16x32_bf16 v[96:99], v[160:163], v[112:115], v[96:99]
  v_mov_b32_dpp v116, v84 row_shl:6 row_mask:0xf bank_mask:0xf
  v_mov_b32_dpp v117, v85 row_shl:6 row_mask:0xf bank_mask:0xf
  v_mfma_f32_16x16x32_bf16 v[100:103], v[164:167], v[112:115], v[100:103]
  v_mov_b32_dpp v118, v86 row_shl:6 row_mask:0xf bank_mask:0xf
  v_mov_b32_dpp v119, v87 row_shl:6 row_mask:0xf bank_mask:0xf
  v_mfma_f32_16x16x32_bf16 v[104:107], v[168:171], v[112:115], v[104:107]
  v_mfma_f32_16x16x32_bf16 v[108:111], v[172:175], v[112:115], v[108:111]
  v_mfma_f32_16x16x32_bf16 v[96:99], v[176:179], v[116:119], v[96:99]
  v_mov_b32_dpp v112, v84 row_shl:8 row_mask:0xf bank_mask:0xf
  v_mov_b32_dpp v113, v85 row_shl:8 row_mask:0xf bank_mask:0xf
  v_mfma_f32_16x16x32_bf16 v[100:103], v[180:183], v[116:119], v[100:103]
  v_mov_b32_dpp v114, v86 row_shl:8 row_mask:0xf bank_mask:0xf
  v_mov_b32_dpp v115, v87 row_shl:8 row_mask:0xf bank_mask:0xf
  v_mfma_f32_16x16x32_bf16 v[104:107], v[184:187], v[116:119], v[104:107]
  v_mfma_f32_16x16x32_bf16 v[108:111], v[188:191], v[116:119], v[108:111]
  v_mfma_f32_16x16x32_bf16 v[96:99], v[192:195], v[112:115], v[96:99]
  v_mfma_f32_16x16x32_bf16 v[100:103], v[196:199], v[112:115], v[100:103]
  v_mfma_f32_16x16x32_bf16 v[104:107], v[200:203], v[112:115], v[104:107]
  v_mfma_f32_16x16x32_bf16 v[108:111], v[204:207], v[112:115], v[108:111]
  s_mov_b32 exec_lo, 0x00030003
  s_mov_b32 exec_hi, 0x00030003
  s_nop 2
  ds_write_b128 v24, v[96:99] offset:4096
  ds_write_b128 v24, v[100:103] offset:4160
  ds_write_b128 v24, v[104:107] offset:4224
  ds_write_b128 v24, v[108:111] offset:4288
  s_mov_b64 exec, -1
  s_waitcnt lgkmcnt(0)
  v_mov_b32 v1, 153740
  v_mov_b32 v2, 1
  s_mov_b64 exec, 1
  ds_add_u32 v1, v2
  s_mov_b64 exec, -1
  s_mov_b32 s9, 2097152
L102_hbar:
  ds_read_b32 v2, v1
  s_waitcnt lgkmcnt(0)
  v_cmp_ne_u32 vcc, 4, v2
  s_nop 0
  s_cbranch_vccz L103_hbard
  s_sub_u32 s9, s9, 1
  s_cbranch_scc0 L102_hbar
L103_hbard:
  s_branch L_Ft
L99_real:
  s_endpgm
L_D:
  s_mul_i32 s10, s38, 491520
  s_lshl_b32 s11, s40, 5
  s_add_u32 s10, s10, s11
  s_add_u32 s10, s80, s10
  s_addc_u32 s11, s81, 0
  v_xor_b32 v1, 0, v19
  v_lshrrev_b32 v2, 1, v1
  v_mul_u32_u24 v2, 96, v2
  v_add_u32 v2, v2, v18
  v_mul_u32_u24 v2, 1280, v2
  v_and_b32 v1, 1, v1
  v_lshl_add_u32 v10, v1, 4, v2
  v_mov_b32 v11, 0
  v_lshl_add_u64 v[10:11], v[10:11], 0, s[10:11]
  v_xor_b32 v1, 4, v19
  v_lshrrev_b32 v2, 1, v1
  v_mul_u32_u24 v2, 96, v2
  v_add_u32 v2, v2, v18
  v_add_u32 v2, 8, v2
  v_mul_u32_u24 v2, 1280, v2
  v_and_b32 v1, 1, v1
  v_lshl_add_u32 v12, v1, 4, v2
  v_mov_b32 v13, 0
  v_lshl_add_u64 v[12:13], v[12:13], 0, s[10:11]
  s_mov_b32 s10, 20480
  s_mov_b32 s11, 0
  s_add_u32 m0, s37, 0
  s_nop 0
  global_load_lds_dwordx4 v[10:11], off
  s_add_u32 m0, m0, 1024
  v_lshl_add_u64 v[10:11], v[10:11], 0, s[10:11]
  global_load_lds_dwordx4 v[12:13], off
  s_add_u32 m0, m0, 1024
  v_lshl_add_u64 v[12:13], v[12:13], 0, s[10:11]
  global_load_lds_dwordx4 v[10:11], off
  s_add_u32 m0, m0, 1024
  v_lshl_add_u64 v[10:11], v[10:11], 0, s[10:11]
  global_load_lds_dwordx4 v[12:13], off
  s_add_u32 m0, m0, 1024
  v_lshl_add_u64 v[12:13], v[12:13], 0, s[10:11]
  s_cmp_lg_u32 s39, 147456
  s_cbranch_scc1 L104_nb
  s_barrier
L104_nb:
  v_bfe_u32 v1, v0, 2, 2
  v_and_b32 v2, 3, v0
  v_lshl_add_u32 v3, v20, 3, v1
  v_lshrrev_b32 v4, 1, v1
  v_and_b32 v5, 1, v20
  v_lshl_add_u32 v4, v5, 1, v4
  v_lshlrev_b32 v3, 7, v3
  v_lshl_add_u32 v3, v2, 3, v3
  v_add_u32 v3, s37, v3
  v_xor_b32 v5, 0, v4
  v_lshl_add_u32 v14, v5, 5, v3
  v_xor_b32 v5, 1, v4
  v_lshl_add_u32 v15, v5, 5, v3
  v_xor_b32 v5, 2, v4
  v_lshl_add_u32 v16, v5, 5, v3
  v_xor_b32 v5, 3, v4
  v_lshl_add_u32 v17, v5, 5, v3
  s_lshl_b32 s10, s38, 9
  s_add_u32 s10, s10, s39
  v_lshlrev_b32 v1, 8, v22
  v_lshl_add_u32 v1, v20, 4, v1
  v_add_u32 v24, s10, v1
  v_lshl_add_u32 v25, v0, 3, s39
  s_lshr_b32 s10, s39, 9
  s_add_u32 s10, s10, 153444
  v_mov_b32 v26, s10
  v_mov_b32 v27, 1
  s_mov_b32 s45, 3
  s_waitcnt vmcnt(0)
  ds_read_b64_tr_b16 v[128:129], v14 offset:0
  ds_read_b64_tr_b16 v[130:131], v14 offset:512
  ds_read_b64_tr_b16 v[132:133], v15 offset:0
  ds_read_b64_tr_b16 v[134:135], v15 offset:512
  ds_read_b64_tr_b16 v[136:137], v16 offset:0
  ds_read_b64_tr_b16 v[138:139], v16 offset:512
  ds_read_b64_tr_b16 v[140:141], v17 offset:0
  ds_read_b64_tr_b16 v[142:143], v17 offset:512
  s_waitcnt lgkmcnt(0)
  s_cmp_lg_u32 s38, 0
  s_cbranch_scc1 L105_noprobe
  s_lshr_b32 s10, s2, 6
  s_lshl_b32 s10, s10, 14
  s_and_b32 s11, s2, 63
  s_lshl_b32 s11, s11, 7
  s_add_u32 s10, s10, s11
  s_add_u32 s10, s10, 999424
  s_add_u32 s10, s90, s10
  s_addc_u32 s11, s91, 0
  s_mov_b32 s12, -1
  s_mov_b32 s13, -1
  s_mov_b32 s9, 12
L106_probe:
  s_memtime s[32:33]
  s_waitcnt lgkmcnt(0)
  s_load_dword s8, s[10:11], 0 glc
  s_waitcnt lgkmcnt(0)
  s_memtime s[34:35]
  s_waitcnt lgkmcnt(0)
  s_sub_u32 s8, s34, s32
  s_min_u32 s12, s12, s8
  s_memtime s[32:33]
  s_waitcnt lgkmcnt(0)
  s_load_dword s8, s[10:11], 8192 glc
  s_waitcnt lgkmcnt(0)
  s_memtime s[34:35]
  s_waitcnt lgkmcnt(0)
  s_sub_u32 s8, s34, s32
  s_min_u32 s13, s13, s8
  s_sub_u32 s9, s9, 1
  s_cmp_lg_u32 s9, 0
  s_cbranch_scc1 L106_probe
  s_cmp_lt_u32 s13, s12
  s_cselect_b32 s8, 8192, 0
  v_mov_b32 v1, 153744
  v_mov_b32 v2, s8
  ds_write_b32 v1, v2
L105_noprobe:
  s_setprio 0
  v_mov_b32 v1, 153752
  s_mov_b32 s9, 2097152
L107_wake:
  ds_read_b64 v[2:3], v1
  s_waitcnt lgkmcnt(0)
  v_cmp_gt_u32 vcc, 1, v3
  s_nop 0
  s_cbranch_vccz L108_awake
  s_sleep 16
  s_sub_u32 s9, s9, 1
  s_cbranch_scc0 L107_wake
L108_awake:
  v_and_b32 v8, 7, v0
  v_cmp_gt_u32 vcc, 32, v0
  s_nop 1
  v_cndmask_b32 v8, v0, v8, vcc
  v_lshlrev_b32 v8, 2, v8
  s_mov_b32 s9, 262144
L109_flag:
  global_load_dword v9, v8, s[88:89] sc1
  s_waitcnt vmcnt(0)
  v_cmp_eq_u32 vcc, 0, v9
  s_nop 0
  s_cbranch_vccz L110_fdone
  s_sleep 8
  s_sub_u32 s9, s9, 1
  s_cbranch_scc0 L109_flag
L110_fdone:
  v_bfe_u32 v30, v0, 3, 1
  v_and_b32 v1, 7, v0
  v_lshlrev_b32 v2, 8, v30
  v_lshl_add_u32 v2, v1, 3, v2
  v_add_u32 v25, s39, v2
  s_lshl_b32 s10, s40, 4
  v_lshl_add_u32 v31, v1, 1, s10
  v_mul_u32_u24 v3, 640, v30
  v_add_lshl_u32 v29, v3, v31, 1
  v_mov_b32 v4, v22
  v_mov_b32 v22, v30
  v_lshrrev_b32 v1, 6, v31
  v_lshl_add_u32 v1, v1, 1, v22
  v_lshlrev_b32 v1, 6, v1
  v_and_b32 v2, 63, v31
  v_add_lshl_u32 v28, v1, v2, 1
  v_add_u32 v28, 114688, v28
  v_mov_b32 v22, v4
  v_add_u32 v8, -101888, v28
  s_mov_b32 s9, 262144
L111_poll:
  buffer_load_dword v44, v8, s[4:7], 0 offen sc1
  s_waitcnt vmcnt(0)
  v_cmp_eq_u32 vcc, -1, v44
  s_nop 0
  s_cbranch_vccz L112_pdone
  s_sleep 32
  s_sub_u32 s9, s9, 1
  s_cbranch_scc0 L111_poll
L112_pdone:
  s_mov_b32 s28, s86
  s_mov_b32 s29, s87
  s_mov_b32 s30, 2560
  s_mov_b32 s31, 0x20000
  v_and_b32 v47, 0xffff0000, v44
  v_lshlrev_b32 v46, 16, v44
  v_bfe_u32 v1, v0, 1, 3
  v_lshlrev_b32 v2, 4, v22
  v_lshl_add_u32 v2, v20, 5, v2
  s_mul_i32 s10, s38, 1536
  s_add_u32 s10, s10, 131072
  v_add_u32 v2, s10, v2
  v_lshl_add_u32 v8, v1, 7, v2
  v_and_b32 v1, 3, v1
  v_lshl_add_u32 v9, v1, 7, v2
  s_mov_b32 s46, 8192
  s_mov_b32 s6, 0
  s_mov_b32 s30, 0
  s_mov_b32 s45, 0
  v_mov_b32 v27, 0
L_Dt:
  v_mov_b32 v1, 153744
  ds_read_b32 v1, v1
  s_waitcnt lgkmcnt(0)
  v_readfirstlane_b32 s47, v1
  s_nop 0
  s_and_b32 s47, s47, 8192
  s_mov_b32 s9, 262144
L113_poll:
  s_nop 1
  buffer_load_dword v40, v28, s[4:7], s47 offen sc1
  s_waitcnt vmcnt(0)
  v_cmp_eq_u32 vcc, -1, v40
  s_nop 0
  s_cbranch_vccz L114_pdone
  s_sub_u32 s9, s9, 1
  s_cbranch_scc0 L113_poll
L114_pdone:
  s_mov_b32 s9, 262144
  s_mov_b64 vcc, -1
L115_spoll:
  s_sub_u32 s9, s9, 1
  s_cbranch_scc1 L116_sdone
  s_mov_b64 exec, vcc
  buffer_load_dwordx4 v[32:35], v8, s[4:7], s47 offen sc1
  buffer_load_dwordx4 v[36:39], v9, s[4:7], s47 offen offset:1024 sc1
  s_mov_b64 exec, -1
  s_waitcnt vmcnt(1)
  v_mfma_f32_16x16x32_bf16 v[96:99], v[128:131], v[32:35], 0
  v_max3_u32 v1, v32, v33, v34
  v_max_u32 v1, v1, v35
  v_mfma_f32_16x16x32_bf16 v[100:103], v[144:147], v[32:35], 0
  v_mov_b32_dpp v48, v32 row_shl:4 row_mask:0xf bank_mask:0xf
  v_mov_b32_dpp v49, v33 row_shl:4 row_mask:0xf bank_mask:0xf
  s_waitcnt vmcnt(0)
  v_mfma_f32_16x16x32_bf16 v[96:99], v[168:171], v[36:39], v[96:99]
  v_max3_u32 v1, v1, v36, v37
  v_max3_u32 v1, v1, v38, v39
  v_cmp_eq_u32 vcc, -1, v1
  v_mfma_f32_16x16x32_bf16 v[100:103], v[140:143], v[36:39], v[100:103]
  v_mov_b32_dpp v50, v34 row_shl:4 row_mask:0xf bank_mask:0xf
  v_mov_b32_dpp v51, v35 row_shl:4 row_mask:0xf bank_mask:0xf
  s_cbranch_vccnz L115_spoll
L116_sdone:
  s_nop 0
  v_mfma_f32_16x16x32_bf16 v[96:99], v[160:163], v[48:51], v[96:99]
  v_mov_b32_dpp v52, v32 row_shl:8 row_mask:0xf bank_mask:0xf
  v_mov_b32_dpp v53, v33 row_shl:8 row_mask:0xf bank_mask:0xf
  v_mov_b32_dpp v54, v34 row_shl:8 row_mask:0xf bank_mask:0xf
  v_mov_b32_dpp v55, v35 row_shl:8 row_mask:0xf bank_mask:0xf
  v_mfma_f32_16x16x32_bf16 v[100:103], v[132:135], v[48:51], v[100:103]
  v_mov_b32_dpp v56, v32 row_shl:12 row_mask:0xf bank_mask:0xf
  v_mov_b32_dpp v57, v33 row_shl:12 row_mask:0xf bank_mask:0xf
  v_mfma_f32_16x16x32_bf16 v[96:99], v[148:151], v[52:55], v[96:99]
  v_mov_b32_dpp v58, v34 row_shl:12 row_mask:0xf bank_mask:0xf
  v_mov_b32_dpp v59, v35 row_shl:12 row_mask:0xf bank_mask:0xf
  v_mfma_f32_16x16x32_bf16 v[100:103], v[164:167], v[52:55], v[100:103]
  v_mov_b32_dpp v60, v36 row_shl:4 row_mask:0xf bank_mask:0xf
  v_mov_b32_dpp v61, v37 row_shl:4 row_mask:0xf bank_mask:0xf
  v_mfma_f32_16x16x32_bf16 v[96:99], v[136:139], v[56:59], v[96:99]
  v_mov_b32_dpp v62, v38 row_shl:4 row_mask:0xf bank_mask:0xf
  v_mov_b32_dpp v63, v39 row_shl:4 row_mask:0xf bank_mask:0xf
  v_mfma_f32_16x16x32_bf16 v[100:103], v[152:155], v[56:59], v[100:103]
  s_nop 0
  v_mfma_f32_16x16x32_bf16 v[96:99], v[156:159], v[60:63], v[96:99]
  v_mfma_f32_16x16x32_bf16 v[100:103], v[172:175], v[60:63], v[100:103]
  v_and_b32 v43, 0xffff0000, v40
  v_lshlrev_b32 v42, 16, v40
  s_nop 5
  v_add_f32_dpp v96, v100, v96 quad_perm:[2,3,0,1] row_mask:0xf bank_mask:0xf
  v_add_f32_dpp v97, v101, v97 quad_perm:[2,3,0,1] row_mask:0xf bank_mask:0xf
  v_add_f32_dpp v98, v102, v98 quad_perm:[2,3,0,1] row_mask:0xf bank_mask:0xf
  v_add_f32_dpp v99, v103, v99 quad_perm:[2,3,0,1] row_mask:0xf bank_mask:0xf
  s_mov_b32 exec_lo, 0x00030003
  s_mov_b32 exec_hi, 0x00030003
  ds_write_b128 v24, v[96:99] offset:0
  s_mov_b64 exec, 1
  ds_add_rtn_u32 v1, v26, v27
  s_mov_b64 exec, -1
  ds_read_b64 v[104:105], v25 offset:0
  ds_read_b64 v[106:107], v25 offset:512
  ds_read_b64 v[108:109], v25 offset:1024
  ds_read_b64 v[110:111], v25 offset:1536
  s_waitcnt lgkmcnt(4)
  v_readfirstlane_b32 s8, v1
  s_waitcnt lgkmcnt(0)
  v_pk_add_f32 v[104:105], v[104:105], v[108:109]
  v_pk_add_f32 v[106:107], v[106:107], v[110:111]
  v_pk_add_f32 v[104:105], v[104:105], v[106:107]
  s_cmp_lg_u32 s8, s45
  s_cbranch_scc1 L_end
  v_cvt_pk_bf16_f32 v98, v104, v105
  v_and_b32 v97, 0xffff0000, v98
  v_lshlrev_b32 v96, 16, v98
  v_pk_mul_f32 v[96:97], v[96:97], v[46:47]
  v_cvt_pk_bf16_f32 v98, v96, v97
  v_and_b32 v97, 0xffff0000, v98
  v_lshlrev_b32 v96, 16, v98
  v_pk_add_f32 v[96:97], v[96:97], v[42:43]
  v_cvt_pk_bf16_f32 v2, v96, v97
  s_mov_b64 exec, 0xffff
  buffer_store_dword v2, v29, s[28:31], 0 offen
  s_cmp_lg_u32 s45, 0
  s_cbranch_scc1 L117_real
  s_mov_b64 exec, -1
  s_mov_b32 s6, 999424
  s_mov_b32 s30, 2560
  s_mov_b32 s45, 3
  v_mov_b32 v27, 1
  s_waitcnt vmcnt(0)
  s_mov_b32 s24, 5
  s_cmp_eq_u32 s38, 3
  s_cbranch_scc1 L_merge
L_back5:
  v_mov_b32 v1, 153752
  v_mov_b32 v2, 1
  s_mov_b64 exec, 1
  ds_add_u32 v1, v2
  s_mov_b64 exec, -1
  s_mov_b32 s9, 2097152
L118_wake:
  ds_read_b64 v[2:3], v1
  s_waitcnt lgkmcnt(0)
  v_lshrrev_b32 v2, 2, v2
  v_mul_u32_u24 v3, v2, v3
  v_cmp_gt_u32 vcc, 64, v3
  s_nop 0
  s_cbranch_vccz L119_awake
  s_sleep 1
  s_sub_u32 s9, s9, 1
  s_cbranch_scc0 L118_wake
L119_awake:
  s_mov_b32 s10, 20480
  s_mov_b32 s11, 0
  s_add_u32 m0, s37, 4096
  s_nop 0
  global_load_lds_dwordx4 v[10:11], off
  s_add_u32 m0, m0, 1024
  v_lshl_add_u64 v[10:11], v[10:11], 0, s[10:11]
  global_load_lds_dwordx4 v[12:13], off
  s_add_u32 m0, m0, 1024
  v_lshl_add_u64 v[12:13], v[12:13], 0, s[10:11]
  v_mov_b32 v1, 153752
  s_mov_b32 s9, 2097152
L120_wake:
  ds_read_b64 v[2:3], v1
  s_waitcnt lgkmcnt(0)
  v_cmp_gt_u32 vcc, 128, v3
  s_nop 0
  s_cbranch_vccz L121_awake
  s_sleep 1
  s_sub_u32 s9, s9, 1
  s_cbranch_scc0 L120_wake
L121_awake:
  global_load_lds_dwordx4 v[10:11], off
  s_add_u32 m0, m0, 1024
  v_lshl_add_u64 v[10:11], v[10:11], 0, s[10:11]
  global_load_lds_dwordx4 v[12:13], off
  s_add_u32 m0, m0, 1024
  v_lshl_add_u64 v[12:13], v[12:13], 0, s[10:11]
  global_load_lds_dwordx4 v[10:11], off
  s_add_u32 m0, m0, 1024
  v_lshl_add_u64 v[10:11], v[10:11], 0, s[10:11]
  global_load_lds_dwordx4 v[12:13], off
  s_add_u32 m0, m0, 1024
  v_lshl_add_u64 v[12:13], v[12:13], 0, s[10:11]
  global_load_lds_dwordx4 v[10:11], off
  s_add_u32 m0, m0, 1024
  v_lshl_add_u64 v[10:11], v[10:11], 0, s[10:11]
  global_load_lds_dwordx4 v[12:13], off
  s_add_u32 m0, m0, 1024
  v_lshl_add_u64 v[12:13], v[12:13], 0, s[10:11]
  s_waitcnt vmcnt(4)
  ds_read_b64_tr_b16 v[144:145], v14 offset:4096
  ds_read_b64_tr_b16 v[146:147], v14 offset:4608
  ds_read_b64_tr_b16 v[148:149], v15 offset:4096
  ds_read_b64_tr_b16 v[150:151], v15 offset:4608
  ds_read_b64_tr_b16 v[152:153], v16 offset:4096
  ds_read_b64_tr_b16 v[154:155], v16 offset:4608
  ds_read_b64_tr_b16 v[156:157], v17 offset:4096
  ds_read_b64_tr_b16 v[158:159], v17 offset:4608
  s_waitcnt vmcnt(0)
  ds_read_b64_tr_b16 v[160:161], v14 offset:8192
  ds_read_b64_tr_b16 v[162:163], v14 offset:8704
  ds_read_b64_tr_b16 v[164:165], v15 offset:8192
  ds_read_b64_tr_b16 v[166:167], v15 offset:8704
  ds_read_b64_tr_b16 v[168:169], v16 offset:8192
  ds_read_b64_tr_b16 v[170:171], v16 offset:8704
  ds_read_b64_tr_b16 v[172:173], v17 offset:8192
  ds_read_b64_tr_b16 v[174:175], v17 offset:8704
  s_waitcnt lgkmcnt(0)
  s_branch L_Dt
L117_real:
  s_endpgm
L_stream:
  s_lshl3_add_u32 s44, s12, 1
  s_mul_i32 s45, s44, 49
  s_lshr_b32 s45, s45, 10
  s_mul_i32 s45, s45, 22
  s_add_u32 s45, s45, s44
  s_mul_i32 s37, s45, 1536
  s_lshl3_add_u32 s44, s12, 2
  s_mul_i32 s45, s44, 49
  s_lshr_b32 s45, s45, 10
  s_mul_i32 s45, s45, 22
  s_add_u32 s45, s45, s44
  s_mul_i32 s38, s45, 1536
  s_lshl3_add_u32 s44, s12, 3
  s_mul_i32 s45, s44, 49
  s_lshr_b32 s45, s45, 10
  s_mul_i32 s45, s45, 22
  s_add_u32 s45, s45, s44
  s_mul_i32 s39, s45, 1536
  s_lshl3_add_u32 s44, s12, 4
  s_mul_i32 s45, s44, 49
  s_lshr_b32 s45, s45, 10
  s_mul_i32 s45, s45, 22
  s_add_u32 s45, s45, s44
  s_mul_i32 s40, s45, 1536
  s_lshl3_add_u32 s44, s12, 5
  s_mul_i32 s45, s44, 49
  s_lshr_b32 s45, s45, 10
  s_mul_i32 s45, s45, 22
  s_add_u32 s45, s45, s44
  s_mul_i32 s41, s45, 1536
  s_lshl3_add_u32 s44, s12, 6
  s_mul_i32 s45, s44, 49
  s_lshr_b32 s45, s45, 10
  s_mul_i32 s45, s45, 22
  s_add_u32 s45, s45, s44
  s_mul_i32 s42, s45, 1536
  s_lshl3_add_u32 s44, s12, 7
  s_mul_i32 s45, s44, 49
  s_lshr_b32 s45, s45, 10
  s_mul_i32 s45, s45, 22
  s_add_u32 s45, s45, s44
  s_mul_i32 s43, s45, 1536
  s_cmp_eq_u32 s12, 7
  s_cselect_b32 s43, 64512, s43
  s_cselect_b32 s44, 33792, 0
  v_bfe_u32 v1, v0, 3, 1
  v_mad_u32_u24 v41, v1, s44, v40
  v_bfe_u32 v1, v0, 3, 2
  v_lshrrev_b32 v2, 5, v0
  v_mul_u32_u24 v3, 84, v2
  v_add_u32 v1, v1, v3
  v_mul_u32_u24 v1, 384, v1
  v_and_b32 v3, 7, v0
  v_lshl_add_u32 v38, v3, 4, v1
  v_mad_u32_u24 v39, v2, s44, v38
  s_mov_b64 s[14:15], s[8:9]
  s_mov_b32 s97, 0x07654321
  s_waitcnt vmcnt(4)
  buffer_load_dwordx4 v[80:83], v40, s[8:11], s37 offen offset:128 nt
  s_waitcnt vmcnt(4)
  buffer_load_dwordx4 v[84:87], v40, s[8:11], s37 offen offset:256 nt
  s_waitcnt vmcnt(4)
  buffer_load_dwordx4 v[88:91], v40, s[8:11], s38 offen offset:0 nt
  s_waitcnt vmcnt(4)
  buffer_load_dwordx4 v[92:95], v40, s[8:11], s38 offen offset:128 nt
  s_waitcnt vmcnt(4)
  buffer_load_dwordx4 v[96:99], v40, s[8:11], s38 offen offset:256 nt
  s_mov_b32 s4, s90
  s_mov_b32 s5, s91
  s_mov_b32 s6, 999424
  s_mov_b32 s7, 0x20000
  s_getpc_b64 s[98:99]
L_pc2:
  s_add_u32 s98, s98, L_tab-L_pc2
  s_addc_u32 s99, s99, 0
  s_lshl_b32 s44, s2, 2
  s_load_dword s93, s[98:99], s44
  s_mov_b32 s16, 0xff00ff00
  s_mov_b32 s17, 0xff00ff00
  s_mov_b32 s18, 16843009
  s_mov_b32 s19, 16843009
  s_mov_b32 s20, 33686018
  s_mov_b32 s21, 33686018
  s_mov_b32 s22, 67372036
  s_mov_b32 s23, 67372036
  s_mov_b32 s24, 134744072
  s_mov_b32 s25, 134744072
  s_mov_b32 s26, 269488144
  s_mov_b32 s27, 269488144
  s_mov_b32 s28, 538976288
  s_mov_b32 s29, 538976288
  s_mov_b32 s30, 1077952576
  s_mov_b32 s31, 1077952576
  s_mov_b32 s32, 2155905152
  s_mov_b32 s33, 2155905152
  s_waitcnt vmcnt(4)
  buffer_load_dwordx4 v[100:103], v40, s[8:11], s39 offen offset:0 nt
  s_waitcnt vmcnt(4)
  buffer_load_dwordx4 v[104:107], v40, s[8:11], s39 offen offset:128 nt
  v_and_b32 v1, 1, v0
  v_lshlrev_b32 v1, 4, v1
  v_mov_b32 v2, 0xffff
  v_lshlrev_b32 v1, v1, v2
  v_bfe_u32 v2, v0, 1, 2
  v_cmp_eq_u32 vcc, 0, v2
  s_nop 1
  v_cndmask_b32 v42, 0, v1, vcc
  v_cmp_eq_u32 vcc, 1, v2
  s_nop 1
  v_cndmask_b32 v43, 0, v1, vcc
  v_cmp_eq_u32 vcc, 2, v2
  s_nop 1
  v_cndmask_b32 v44, 0, v1, vcc
  v_cmp_eq_u32 vcc, 3, v2
  s_nop 1
  v_cndmask_b32 v45, 0, v1, vcc
  s_waitcnt vmcnt(4)
  buffer_load_dwordx4 v[108:111], v40, s[8:11], s39 offen offset:256 nt
  s_waitcnt vmcnt(4)
  buffer_load_dwordx4 v[112:115], v40, s[8:11], s40 offen offset:0 nt
  v_bfe_u32 v1, v0, 3, 2
  v_mul_u32_u24 v1, 6144, v1
  v_lshrrev_b32 v2, 5, v0
  v_lshl_add_u32 v1, v2, 7, v1
  v_and_b32 v2, 7, v0
  v_lshl_add_u32 v1, v2, 4, v1
  s_mul_i32 s44, s13, 768
  s_add_u32 s44, s44, 16384
  v_add_u32 v50, s44, v1
  s_mul_i32 s35, s3, 12288
  s_add_u32 s35, s35, 98304
  v_add_u32 v51, s35, v51
  v_lshrrev_b32 v1, 4, v0
  v_lshlrev_b32 v1, 5, v1
  s_lshl3_add_u32 s44, s3, 153792
  v_add_u32 v52, s44, v1
  v_and_b32 v54, 7, v0
  v_cmp_gt_u32 vcc, 32, v0
  s_nop 1
  v_cndmask_b32 v54, v0, v54, vcc
  v_lshlrev_b32 v54, 2, v54
  s_waitcnt vmcnt(4)
  buffer_load_dwordx4 v[116:119], v40, s[8:11], s40 offen offset:128 nt
  s_waitcnt vmcnt(4)
  buffer_load_dwordx4 v[120:123], v40, s[8:11], s40 offen offset:256 nt
  s_lshr_b32 s45, s2, 4
  s_and_b32 s44, s2, 15
  s_xor_b32 s44, s44, s45
  s_bfe_u32 s46, s2, 0x20001
  s_xor_b32 s46, s46, s3
  s_or_b32 s92, s44, s46
  s_lshl_b32 s45, s45, 7
  s_add_u32 s45, s45, 40960
  v_mov_b32 v58, s45
  s_mov_b32 s100, 0
  s_add_u32 s64, s90, 40960
  s_addc_u32 s65, s91, 0
  s_waitcnt vmcnt(4)
  buffer_load_dwordx4 v[124:127], v40, s[8:11], s41 offen offset:0 nt
  s_waitcnt vmcnt(4)
  buffer_load_dwordx4 v[128:131], v40, s[8:11], s41 offen offset:128 nt
  s_waitcnt lgkmcnt(0)
  s_mov_b32 s101, -368
  s_bitcmp1_b32 s93, 30
  s_cselect_b32 s101, 192, s101
  s_bitcmp1_b32 s93, 31
  s_cselect_b32 s101, -176, s101
  v_lshrrev_b32 v1, 5, v0
  v_mul_u32_u24 v1, 768, v1
  v_bfe_u32 v2, v0, 4, 1
  v_lshl_add_u32 v1, v2, 7, v1
  v_and_b32 v2, 7, v0
  v_lshl_add_u32 v1, v2, 4, v1
  v_add_u32 v62, s35, v1
  s_and_b32 s44, s2, 7
  s_lshr_b32 s45, s2, 3
  s_lshl_b32 s44, s44, 5
  s_add_u32 s44, s44, s45
  s_mul_i32 s44, s44, 384
  s_add_u32 s44, s44, 212992
  v_and_b32 v1, 0x31, v0
  v_bfe_u32 v2, v0, 2, 2
  v_lshl_add_u32 v1, v2, 1, v1
  v_bfe_u32 v2, v0, 1, 1
  v_lshl_add_u32 v1, v2, 3, v1
  v_lshl_add_u32 v57, v0, 3, s44
  v_min_u32 v1, 47, v1
  v_lshlrev_b32 v1, 4, v1
  v_add_u32 v56, 109056, v1
  s_mov_b32 s94, 0x00ff00ff
  s_mov_b32 s95, 0xff00ff00
  v_mov_b32 v55, 1
  v_mov_b32 v60, 1
  v_mov_b32 v63, 153728
  s_waitcnt vmcnt(4)
  buffer_load_dwordx4 v[132:135], v40, s[8:11], s41 offen offset:256 nt
  s_bitcmp1_b32 s93, 29
  s_cselect_b64 vcc, -1, 0
  s_waitcnt vmcnt(6)
  s_cbranch_vccnz L122_y
  s_waitcnt vmcnt(4)
L122_y:
  buffer_load_dwordx4 v[136:139], v40, s[8:11], s42 offen offset:0 nt
  s_waitcnt vmcnt(6)
  s_cbranch_vccnz L123_y
  s_waitcnt vmcnt(4)
L123_y:
  buffer_load_dwordx4 v[140:143], v40, s[8:11], s42 offen offset:128 nt
  s_waitcnt vmcnt(6)
  s_cbranch_vccnz L124_y
  s_waitcnt vmcnt(4)
L124_y:
  buffer_load_dwordx4 v[144:147], v40, s[8:11], s42 offen offset:256 nt
  s_waitcnt vmcnt(6)
  s_cbranch_vccnz L125_y
  s_waitcnt vmcnt(4)
L125_y:
  buffer_load_dwordx4 v[148:151], v41, s[8:11], s43 offen offset:0 nt
  s_waitcnt vmcnt(6)
  s_cbranch_vccnz L126_y
  s_waitcnt vmcnt(4)
L126_y:
  buffer_load_dwordx4 v[152:155], v41, s[8:11], s43 offen offset:128 nt
  s_waitcnt vmcnt(6)
  s_cbranch_vccnz L127_y
  s_waitcnt vmcnt(4)
L127_y:
  buffer_load_dwordx4 v[156:159], v41, s[8:11], s43 offen offset:256 nt
  s_and_b32 s46, s97, 7
  s_lshr_b32 s97, s97, 4
  s_mul_i32 s46, s46, 25165824
  s_add_u32 s8, s14, s46
  s_addc_u32 s9, s15, 0
  s_mov_b64 exec, 1
  ds_add_u32 v63, v55 offset:20
  s_mov_b64 exec, -1
  s_waitcnt vmcnt(6)
  s_cbranch_vccnz L128_y
  s_waitcnt vmcnt(4)
L128_y:
  buffer_load_dwordx4 v[160:163], v40, s[8:11], s36 offen offset:0 nt
  global_load_dword v53, v54, s[88:89] sc1
  s_waitcnt vmcnt(7)
  s_cbranch_vccnz L129_y
  s_waitcnt vmcnt(5)
L129_y:
  buffer_load_dwordx4 v[164:167], v40, s[8:11], s36 offen offset:128 nt
  s_waitcnt vmcnt(7)
  s_cbranch_vccnz L130_y
  s_waitcnt vmcnt(5)
L130_y:
  buffer_load_dwordx4 v[168:171], v40, s[8:11], s36 offen offset:256 nt
  s_waitcnt vmcnt(7)
  s_cbranch_vccnz L131_y
  s_waitcnt vmcnt(5)
L131_y:
  buffer_load_dwordx4 v[172:175], v40, s[8:11], s37 offen offset:0 nt
  s_waitcnt vmcnt(7)
  s_cbranch_vccnz L132_y
  s_waitcnt vmcnt(5)
L132_y:
  buffer_load_dwordx4 v[176:179], v40, s[8:11], s37 offen offset:128 nt
  s_waitcnt vmcnt(7)
  s_cbranch_vccnz L133_y
  s_waitcnt vmcnt(5)
L133_y:
  buffer_load_dwordx4 v[180:183], v40, s[8:11], s37 offen offset:256 nt
  s_waitcnt vmcnt(6)
  s_cbranch_vccnz L134_y
  s_waitcnt vmcnt(4)
L134_y:
  buffer_load_dwordx4 v[184:187], v40, s[8:11], s38 offen offset:0 nt
  s_waitcnt vmcnt(6)
  s_cbranch_vccnz L135_y
  s_waitcnt vmcnt(4)
L135_y:
  buffer_load_dwordx4 v[188:191], v40, s[8:11], s38 offen offset:128 nt
  s_waitcnt vmcnt(6)
  s_cbranch_vccnz L136_y
  s_waitcnt vmcnt(4)
L136_y:
  buffer_load_dwordx4 v[192:195], v40, s[8:11], s38 offen offset:256 nt
  s_waitcnt vmcnt(6)
  s_cbranch_vccnz L137_y
  s_waitcnt vmcnt(4)
L137_y:
  buffer_load_dwordx4 v[196:199], v40, s[8:11], s39 offen offset:0 nt
  s_waitcnt vmcnt(6)
  s_cbranch_vccnz L138_y
  s_waitcnt vmcnt(4)
L138_y:
  buffer_load_dwordx4 v[200:203], v40, s[8:11], s39 offen offset:128 nt
  s_waitcnt vmcnt(6)
  s_cbranch_vccnz L139_y
  s_waitcnt vmcnt(4)
L139_y:
  buffer_load_dwordx4 v[204:207], v40, s[8:11], s39 offen offset:256 nt
  s_waitcnt vmcnt(6)
  s_cbranch_vccnz L140_y
  s_waitcnt vmcnt(4)
L140_y:
  buffer_load_dwordx4 v[208:211], v40, s[8:11], s40 offen offset:0 nt
  s_waitcnt vmcnt(6)
  s_cbranch_vccnz L141_y
  s_waitcnt vmcnt(4)
L141_y:
  buffer_load_dwordx4 v[212:215], v40, s[8:11], s40 offen offset:128 nt
  s_waitcnt vmcnt(6)
  s_cbranch_vccnz L142_y
  s_waitcnt vmcnt(4)
L142_y:
  buffer_load_dwordx4 v[216:219], v40, s[8:11], s40 offen offset:256 nt
  s_waitcnt vmcnt(6)
  s_cbranch_vccnz L143_y
  s_waitcnt vmcnt(4)
L143_y:
  buffer_load_dwordx4 v[220:223], v40, s[8:11], s41 offen offset:0 nt
  s_waitcnt vmcnt(6)
  s_cbranch_vccnz L144_y
  s_waitcnt vmcnt(4)
L144_y:
  buffer_load_dwordx4 v[224:227], v40, s[8:11], s41 offen offset:128 nt
  s_waitcnt vmcnt(6)
  s_cbranch_vccnz L145_y
  s_waitcnt vmcnt(4)
L145_y:
  buffer_load_dwordx4 v[228:231], v40, s[8:11], s41 offen offset:256 nt
  s_waitcnt vmcnt(6)
  s_cbranch_vccnz L146_y
  s_waitcnt vmcnt(4)
L146_y:
  buffer_load_dwordx4 v[232:235], v40, s[8:11], s42 offen offset:0 nt
  v_cmp_eq_u32 vcc, 0, v53
  s_nop 0
  s_cbranch_vccz L147_fok
  s_mov_b32 s99, 262144
L148_flag:
  global_load_dword v53, v54, s[88:89] sc1
  s_waitcnt vmcnt(0)
  v_cmp_eq_u32 vcc, 0, v53
  s_nop 0
  s_cbranch_vccz L149_fdone
  s_sleep 8
  s_sub_u32 s99, s99, 1
  s_cbranch_scc0 L148_flag
L149_fdone:
L147_fok:
  buffer_load_dwordx4 v[16:19], v50, s[4:7], 0 offen offset:0 sc1
  buffer_load_dwordx4 v[20:23], v50, s[4:7], 0 offen offset:256 sc1
  buffer_load_dwordx4 v[24:27], v50, s[4:7], 0 offen offset:512 sc1
  s_bitcmp1_b32 s93, 29
  s_cselect_b64 vcc, -1, 0
  s_waitcnt vmcnt(9)
  s_cbranch_vccnz L150_y
  s_waitcnt vmcnt(7)
L150_y:
  buffer_load_dwordx4 v[236:239], v40, s[8:11], s42 offen offset:128 nt
  s_waitcnt vmcnt(9)
  s_cbranch_vccnz L151_y
  s_waitcnt vmcnt(7)
L151_y:
  buffer_load_dwordx4 v[240:243], v40, s[8:11], s42 offen offset:256 nt
  s_waitcnt vmcnt(9)
  s_cbranch_vccnz L152_y
  s_waitcnt vmcnt(7)
L152_y:
  buffer_load_dwordx4 v[244:247], v41, s[8:11], s43 offen offset:0 nt
  s_waitcnt vmcnt(9)
  s_cbranch_vccnz L153_y
  s_waitcnt vmcnt(7)
L153_y:
  buffer_load_dwordx4 v[248:251], v41, s[8:11], s43 offen offset:128 nt
  s_waitcnt vmcnt(9)
  s_cbranch_vccnz L154_y
  s_waitcnt vmcnt(7)
L154_y:
  buffer_load_dwordx4 v[252:255], v41, s[8:11], s43 offen offset:256 nt
  s_and_b32 s46, s97, 7
  s_lshr_b32 s97, s97, 4
  s_mul_i32 s46, s46, 25165824
  s_add_u32 s8, s14, s46
  s_addc_u32 s9, s15, 0
  s_waitcnt vmcnt(5)
  v_max3_u32 v1, v16, v17, v18
  v_max3_u32 v1, v1, v19, v20
  v_max3_u32 v1, v1, v21, v22
  v_max3_u32 v1, v1, v23, v24
  v_max3_u32 v1, v1, v25, v26
  v_max_u32 v1, v1, v27
  v_cmp_eq_u32 vcc, -1, v1
  s_nop 0
  s_cbranch_vccz L155_qok
  s_mov_b32 s99, 262144
L156_poll:
  buffer_load_dwordx4 v[16:19], v50, s[4:7], 0 offen offset:0 sc1
  buffer_load_dwordx4 v[20:23], v50, s[4:7], 0 offen offset:256 sc1
  buffer_load_dwordx4 v[24:27], v50, s[4:7], 0 offen offset:512 sc1
  s_waitcnt vmcnt(0)
  v_max3_u32 v1, v16, v17, v18
  v_max3_u32 v1, v1, v19, v20
  v_max3_u32 v1, v1, v21, v22
  v_max3_u32 v1, v1, v23, v24
  v_max3_u32 v1, v1, v25, v26
  v_max_u32 v1, v1, v27
  v_cmp_eq_u32 vcc, -1, v1
  s_nop 0
  s_cbranch_vccz L157_pdone
  s_sub_u32 s99, s99, 1
  s_cbranch_scc0 L156_poll
L157_pdone:
L155_qok:
  v_lshl_add_u32 v1, v0, 4, s35
  ds_write_b128 v1, v[16:19] offset:0
  ds_write_b128 v1, v[20:23] offset:1024
  ds_write_b128 v1, v[24:27] offset:2048
  ds_read_b128 v[16:19], v51 offset:0
  ds_read_b128 v[20:23], v51 offset:1024
  ds_read_b128 v[24:27], v51 offset:2048
  s_memrealtime s[0:1]
  s_mov_b32 s87, 893
  s_mov_b32 s86, 0
  s_mov_b32 s98, 1
  s_mov_b64 vcc, 0
  v_add_u32 v58, 0, v58
  s_waitcnt lgkmcnt(0)
  s_add_u32 s100, s0, 100000
  s_sub_u32 s44, s0, 60
  s_bitcmp1_b32 s93, 29
  s_cselect_b32 s100, s44, s100
  s_cselect_b64 vcc, -1, 0
  s_lshl_b32 s100, s100, 4
  s_mov_b32 s99, 0
L_kloop:
  s_cmp_lg_u32 s99, 3
  s_cbranch_scc1 L_knosw
  s_add_u32 s14, s68, s34
  s_addc_u32 s15, s69, 0
  s_mov_b32 s97, 68302183
  s_and_b32 s46, s97, 7
  s_lshr_b32 s97, s97, 4
  s_mul_i32 s46, s46, 25165824
  s_add_u32 s8, s14, s46
  s_addc_u32 s9, s15, 0
  v_mov_b32 v40, v38
  v_mov_b32 v41, v39
  v_mov_b32 v7, 1
  s_mov_b64 exec, 1
  ds_add_u32 v63, v7 offset:28
  s_mov_b64 exec, -1
  s_setprio 2
L_knosw:
  s_waitcnt lgkmcnt(0)
  v_mfma_f32_16x16x32_bf16 v[8:11], v[64:67], v[16:19], 0
  s_waitcnt vmcnt(6)
  s_cbranch_vccnz L158_x
  s_waitcnt vmcnt(4)
L158_x:
  buffer_load_dwordx4 v[64:67], v40, s[8:11], s36 offen offset:0 nt
  v_mfma_f32_16x16x32_bf16 v[8:11], v[68:71], v[20:23], v[8:11]
  s_waitcnt vmcnt(6)
  s_cbranch_vccnz L159_x
  s_waitcnt vmcnt(4)
L159_x:
  buffer_load_dwordx4 v[68:71], v40, s[8:11], s36 offen offset:128 nt
  v_mfma_f32_16x16x32_bf16 v[8:11], v[72:75], v[24:27], v[8:11]
  s_waitcnt vmcnt(6)
  s_cbranch_vccnz L160_x
  s_waitcnt vmcnt(4)
L160_x:
  buffer_load_dwordx4 v[72:75], v40, s[8:11], s36 offen offset:256 nt
  s_memrealtime s[0:1]
  v_mfma_f32_16x16x32_bf16 v[12:15], v[76:79], v[16:19], 0
  s_waitcnt vmcnt(6)
  s_cbranch_vccnz L161_x
  s_waitcnt vmcnt(4)
L161_x:
  buffer_load_dwordx4 v[76:79], v40, s[8:11], s37 offen offset:0 nt
  s_waitcnt lgkmcnt(0)
  s_lshl4_add_u32 s44, s0, s101
  s_sub_u32 s44, s44, s100
  s_add_u32 s100, s100, s87
  s_cmp_gt_i32 s44, 0
  s_cselect_b64 vcc, -1, 0
  s_cmp_lg_u32 s92, 0
  s_cbranch_scc1 L162_nopub
  v_mov_b32 v59, s0
  s_mov_b64 exec, 1
  buffer_store_dword v59, v58, s[4:7], 0 offen sc1
  s_mov_b64 exec, -1
  v_add_u32 v58, 2048, v58
L162_nopub:
  v_cndmask_b32 v2, v8, v10, s[16:17]
  v_cndmask_b32 v3, v9, v11, s[16:17]
  s_nop 1
  v_add_f32_dpp v2, v3, v2 quad_perm:[1,0,3,2] row_mask:0xf bank_mask:0xf
  v_cndmask_b32 v36, v36, v2, s[18:19]
  v_mfma_f32_16x16x32_bf16 v[12:15], v[80:83], v[20:23], v[12:15]
  s_waitcnt vmcnt(6)
  s_cbranch_vccnz L163_x
  s_waitcnt vmcnt(4)
L163_x:
  buffer_load_dwordx4 v[80:83], v40, s[8:11], s37 offen offset:128 nt
  v_mfma_f32_16x16x32_bf16 v[12:15], v[84:87], v[24:27], v[12:15]
  s_waitcnt vmcnt(6)
  s_cbranch_vccnz L164_x
  s_waitcnt vmcnt(4)
L164_x:
  buffer_load_dwordx4 v[84:87], v40, s[8:11], s37 offen offset:256 nt
  v_mfma_f32_16x16x32_bf16 v[8:11], v[88:91], v[16:19], 0
  s_waitcnt vmcnt(6)
  s_cbranch_vccnz L165_x
  s_waitcnt vmcnt(4)
L165_x:
  buffer_load_dwordx4 v[88:91], v40, s[8:11], s38 offen offset:0 nt
  s_memrealtime s[0:1]
  v_cndmask_b32 v2, v12, v14, s[16:17]
  v_cndmask_b32 v3, v13, v15, s[16:17]
  s_nop 1
  v_add_f32_dpp v2, v2, v3 quad_perm:[1,0,3,2] row_mask:0xf bank_mask:0xf
  v_cndmask_b32 v36, v36, v2, s[20:21]
  v_mfma_f32_16x16x32_bf16 v[8:11], v[92:95], v[20:23], v[8:11]
  s_waitcnt vmcnt(6)
  s_cbranch_vccnz L166_x
  s_waitcnt vmcnt(4)
L166_x:
  buffer_load_dwordx4 v[92:95], v40, s[8:11], s38 offen offset:128 nt
  s_waitcnt lgkmcnt(0)
  s_lshl4_add_u32 s44, s0, s101
  s_sub_u32 s44, s44, s100
  s_add_u32 s100, s100, s87
  s_cmp_gt_i32 s44, 0
  s_cselect_b64 vcc, -1, 0
  v_mfma_f32_16x16x32_bf16 v[8:11], v[96:99], v[24:27], v[8:11]
  s_waitcnt vmcnt(6)
  s_cbranch_vccnz L167_x
  s_waitcnt vmcnt(4)
L167_x:
  buffer_load_dwordx4 v[96:99], v40, s[8:11], s38 offen offset:256 nt
  v_mfma_f32_16x16x32_bf16 v[12:15], v[100:103], v[16:19], 0
  s_waitcnt vmcnt(6)
  s_cbranch_vccnz L168_x
  s_waitcnt vmcnt(4)
L168_x:
  buffer_load_dwordx4 v[100:103], v40, s[8:11], s39 offen offset:0 nt
  s_nop 0
  v_cndmask_b32 v2, v8, v10, s[16:17]
  v_cndmask_b32 v3, v9, v11, s[16:17]
  s_nop 1
  v_add_f32_dpp v2, v3, v2 quad_perm:[1,0,3,2] row_mask:0xf bank_mask:0xf
  v_cndmask_b32 v36, v36, v2, s[22:23]
  v_mfma_f32_16x16x32_bf16 v[12:15], v[104:107], v[20:23], v[12:15]
  s_waitcnt vmcnt(6)
  s_cbranch_vccnz L169_x
  s_waitcnt vmcnt(4)
L169_x:
  buffer_load_dwordx4 v[104:107], v40, s[8:11], s39 offen offset:128 nt
  s_memrealtime s[0:1]
  v_mfma_f32_16x16x32_bf16 v[12:15], v[108:111], v[24:27], v[12:15]
  s_waitcnt vmcnt(6)
  s_cbranch_vccnz L170_x
  s_waitcnt vmcnt(4)
L170_x:
  buffer_load_dwordx4 v[108:111], v40, s[8:11], s39 offen offset:256 nt
  s_waitcnt lgkmcnt(0)
  s_lshl4_add_u32 s44, s0, s101
  s_sub_u32 s44, s44, s100
  s_add_u32 s100, s100, s87
  s_cmp_gt_i32 s44, 0
  s_cselect_b64 vcc, -1, 0
  v_mfma_f32_16x16x32_bf16 v[8:11], v[112:115], v[16:19], 0
  s_waitcnt vmcnt(6)
  s_cbranch_vccnz L171_x
  s_waitcnt vmcnt(4)
L171_x:
  buffer_load_dwordx4 v[112:115], v40, s[8:11], s40 offen offset:0 nt
  v_cndmask_b32 v2, v12, v14, s[16:17]
  v_cndmask_b32 v3, v13, v15, s[16:17]
  s_nop 1
  v_add_f32_dpp v2, v2, v3 quad_perm:[1,0,3,2] row_mask:0xf bank_mask:0xf
  v_cndmask_b32 v36, v36, v2, s[24:25]
  v_mfma_f32_16x16x32_bf16 v[8:11], v[116:119], v[20:23], v[8:11]
  s_waitcnt vmcnt(6)
  s_cbranch_vccnz L172_x
  s_waitcnt vmcnt(4)
L172_x:
  buffer_load_dwordx4 v[116:119], v40, s[8:11], s40 offen offset:128 nt
  v_mfma_f32_16x16x32_bf16 v[8:11], v[120:123], v[24:27], v[8:11]
  s_waitcnt vmcnt(6)
  s_cbranch_vccnz L173_x
  s_waitcnt vmcnt(4)
L173_x:
  buffer_load_dwordx4 v[120:123], v40, s[8:11], s40 offen offset:256 nt
  s_memrealtime s[0:1]
  v_mfma_f32_16x16x32_bf16 v[12:15], v[124:127], v[16:19], 0
  s_waitcnt vmcnt(6)
  s_cbranch_vccnz L174_x
  s_waitcnt vmcnt(4)
L174_x:
  buffer_load_dwordx4 v[124:127], v40, s[8:11], s41 offen offset:0 nt
  s_waitcnt lgkmcnt(0)
  s_lshl4_add_u32 s44, s0, s101
  s_sub_u32 s44, s44, s100
  s_add_u32 s100, s100, s87
  s_cmp_gt_i32 s44, 0
  s_cselect_b64 vcc, -1, 0
  s_load_dword s70, s[64:65], 0
  s_load_dword s71, s[64:65], 128
  s_load_dword s72, s[64:65], 256
  s_load_dword s73, s[64:65], 384
  s_load_dword s74, s[64:65], 512
  s_load_dword s75, s[64:65], 640
  s_load_dword s76, s[64:65], 768
  s_load_dword s77, s[64:65], 896
  s_load_dword s78, s[64:65], 1024
  s_load_dword s79, s[64:65], 1152
  s_load_dword s80, s[64:65], 1280
  s_load_dword s81, s[64:65], 1408
  s_load_dword s82, s[64:65], 1536
  s_load_dword s83, s[64:65], 1664
  s_load_dword s84, s[64:65], 1792
  s_load_dword s85, s[64:65], 1920
  v_cndmask_b32 v2, v8, v10, s[16:17]
  v_cndmask_b32 v3, v9, v11, s[16:17]
  s_nop 1
  v_add_f32_dpp v2, v3, v2 quad_perm:[1,0,3,2] row_mask:0xf bank_mask:0xf
  v_cndmask_b32 v36, v36, v2, s[26:27]
  v_mfma_f32_16x16x32_bf16 v[12:15], v[128:131], v[20:23], v[12:15]
  s_waitcnt vmcnt(6)
  s_cbranch_vccnz L175_x
  s_waitcnt vmcnt(4)
L175_x:
  buffer_load_dwordx4 v[128:131], v40, s[8:11], s41 offen offset:128 nt
  v_mfma_f32_16x16x32_bf16 v[12:15], v[132:135], v[24:27], v[12:15]
  s_waitcnt vmcnt(6)
  s_cbranch_vccnz L176_x
  s_waitcnt vmcnt(4)
L176_x:
  buffer_load_dwordx4 v[132:135], v40, s[8:11], s41 offen offset:256 nt
  v_mfma_f32_16x16x32_bf16 v[8:11], v[136:139], v[16:19], 0
  s_waitcnt vmcnt(6)
  s_cbranch_vccnz L177_x
  s_waitcnt vmcnt(4)
L177_x:
  buffer_load_dwordx4 v[136:139], v40, s[8:11], s42 offen offset:0 nt
  s_memrealtime s[0:1]
  v_cndmask_b32 v2, v12, v14, s[16:17]
  v_cndmask_b32 v3, v13, v15, s[16:17]
  s_nop 1
  v_add_f32_dpp v2, v2, v3 quad_perm:[1,0,3,2] row_mask:0xf bank_mask:0xf
  v_cndmask_b32 v36, v36, v2, s[28:29]
  v_mfma_f32_16x16x32_bf16 v[8:11], v[140:143], v[20:23], v[8:11]
  s_waitcnt vmcnt(6)
  s_cbranch_vccnz L178_x
  s_waitcnt vmcnt(4)
L178_x:
  buffer_load_dwordx4 v[140:143], v40, s[8:11], s42 offen offset:128 nt
  s_waitcnt lgkmcnt(0)
  s_lshl4_add_u32 s44, s0, s101
  s_sub_u32 s44, s44, s100
  s_add_u32 s100, s100, s87
  s_cmp_gt_i32 s44, 0
  s_cselect_b64 vcc, -1, 0
  s_add_u32 s64, s64, 2048
  s_addc_u32 s65, s65, 0
  s_mov_b32 s45, 0
  s_sub_u32 s47, s44, s101
  s_max_i32 s47, s47, 0
  s_lshr_b32 s47, s47, 4
  s_add_u32 s47, s47, 90
  s_sub_u32 s47, s0, s47
  s_cmp_eq_u32 s70, -1
  s_cselect_b32 s70, s47, s70
  s_add_u32 s45, s45, s70
  s_cmp_eq_u32 s71, -1
  s_cselect_b32 s71, s47, s71
  s_add_u32 s45, s45, s71
  s_cmp_eq_u32 s72, -1
  s_cselect_b32 s72, s47, s72
  s_add_u32 s45, s45, s72
  s_cmp_eq_u32 s73, -1
  s_cselect_b32 s73, s47, s73
  s_add_u32 s45, s45, s73
  s_cmp_eq_u32 s74, -1
  s_cselect_b32 s74, s47, s74
  s_add_u32 s45, s45, s74
  s_cmp_eq_u32 s75, -1
  s_cselect_b32 s75, s47, s75
  s_add_u32 s45, s45, s75
  s_cmp_eq_u32 s76, -1
  s_cselect_b32 s76, s47, s76
  s_add_u32 s45, s45, s76
  s_cmp_eq_u32 s77, -1
  s_cselect_b32 s77, s47, s77
  s_add_u32 s45, s45, s77
  s_cmp_eq_u32 s78, -1
  s_cselect_b32 s78, s47, s78
  s_add_u32 s45, s45, s78
  s_cmp_eq_u32 s79, -1
  s_cselect_b32 s79, s47, s79
  s_add_u32 s45, s45, s79
  s_cmp_eq_u32 s80, -1
  s_cselect_b32 s80, s47, s80
  s_add_u32 s45, s45, s80
  s_cmp_eq_u32 s81, -1
  s_cselect_b32 s81, s47, s81
  s_add_u32 s45, s45, s81
  s_cmp_eq_u32 s82, -1
  s_cselect_b32 s82, s47, s82
  s_add_u32 s45, s45, s82
  s_cmp_eq_u32 s83, -1
  s_cselect_b32 s83, s47, s83
  s_add_u32 s45, s45, s83
  s_cmp_eq_u32 s84, -1
  s_cselect_b32 s84, s47, s84
  s_add_u32 s45, s45, s84
  s_cmp_eq_u32 s85, -1
  s_cselect_b32 s85, s47, s85
  s_add_u32 s45, s45, s85
  s_sub_u32 s44, s45, s86
  s_mov_b32 s86, s45
  s_mul_i32 s1, s87, 6
  s_sub_u32 s44, s44, s1
  s_min_i32 s44, s44, 640
  s_max_i32 s44, s44, -640
  s_mul_hi_i32 s44, s44, 357913941
  s_add_u32 s44, s44, s87
  s_sub_u32 s98, s98, 1
  s_cselect_b32 s87, s44, s87
  s_cselect_b32 s98, 0, s98
  s_mul_i32 s44, s87, 5
  s_add_u32 s100, s45, s44
  v_mfma_f32_16x16x32_bf16 v[8:11], v[144:147], v[24:27], v[8:11]
  s_waitcnt vmcnt(6)
  s_cbranch_vccnz L179_x
  s_waitcnt vmcnt(4)
L179_x:
  buffer_load_dwordx4 v[144:147], v40, s[8:11], s42 offen offset:256 nt
  v_mfma_f32_16x16x32_bf16 v[12:15], v[148:151], v[16:19], 0
  ds_read_b128 v[16:19], v51 offset:128
  s_waitcnt vmcnt(6)
  s_cbranch_vccnz L180_x
  s_waitcnt vmcnt(4)
L180_x:
  buffer_load_dwordx4 v[148:151], v41, s[8:11], s43 offen offset:0 nt
  v_cndmask_b32 v2, v8, v10, s[16:17]
  v_cndmask_b32 v3, v9, v11, s[16:17]
  s_nop 1
  v_add_f32_dpp v2, v3, v2 quad_perm:[1,0,3,2] row_mask:0xf bank_mask:0xf
  v_cndmask_b32 v36, v36, v2, s[30:31]
  v_mfma_f32_16x16x32_bf16 v[12:15], v[152:155], v[20:23], v[12:15]
  ds_read_b128 v[20:23], v51 offset:1152
  s_waitcnt vmcnt(6)
  s_cbranch_vccnz L181_x
  s_waitcnt vmcnt(4)
L181_x:
  buffer_load_dwordx4 v[152:155], v41, s[8:11], s43 offen offset:128 nt
  s_memrealtime s[0:1]
  v_mfma_f32_16x16x32_bf16 v[12:15], v[156:159], v[24:27], v[12:15]
  ds_read_b128 v[24:27], v51 offset:2176
  s_waitcnt vmcnt(6)
  s_cbranch_vccnz L182_x
  s_waitcnt vmcnt(4)
L182_x:
  buffer_load_dwordx4 v[156:159], v41, s[8:11], s43 offen offset:256 nt
  s_and_b32 s46, s97, 7
  s_lshr_b32 s97, s97, 4
  s_mul_i32 s46, s46, 25165824
  s_add_u32 s8, s14, s46
  s_addc_u32 s9, s15, 0
  s_waitcnt lgkmcnt(0)
  s_lshl4_add_u32 s44, s0, s101
  s_sub_u32 s44, s44, s100
  s_add_u32 s100, s100, s87
  s_cmp_gt_i32 s44, 0
  s_cselect_b64 vcc, -1, 0
  s_waitcnt lgkmcnt(0)
  v_mfma_f32_16x16x32_bf16 v[8:11], v[160:163], v[16:19], 0
  s_waitcnt vmcnt(6)
  s_cbranch_vccnz L183_x
  s_waitcnt vmcnt(4)
L183_x:
  buffer_load_dwordx4 v[160:163], v40, s[8:11], s36 offen offset:0 nt
  v_cndmask_b32 v2, v12, v14, s[16:17]
  v_cndmask_b32 v3, v13, v15, s[16:17]
  s_nop 1
  v_add_f32_dpp v2, v2, v3 quad_perm:[1,0,3,2] row_mask:0xf bank_mask:0xf
  v_cndmask_b32 v36, v36, v2, s[32:33]
  v_cvt_pk_bf16_f32 v36, v36, v36
  v_lshlrev_b32 v36, 16, v36
  v_mul_f32 v36, 0x3d93cd3a, v36
  v_cvt_pk_bf16_f32 v36, v36, v36
  v_mov_b32 v28, v30
  v_mov_b32 v29, v31
  v_mov_b32 v30, v32
  v_mov_b32 v31, v33
  v_mov_b32 v32, v34
  v_mov_b32 v33, v35
  v_lshlrev_b32 v34, 16, v36
  v_mfma_f32_16x16x32_bf16 v[8:11], v[164:167], v[20:23], v[8:11]
  s_waitcnt vmcnt(6)
  s_cbranch_vccnz L184_x
  s_waitcnt vmcnt(4)
L184_x:
  buffer_load_dwordx4 v[164:167], v40, s[8:11], s36 offen offset:128 nt
  v_mfma_f32_16x16x32_bf16 v[8:11], v[168:171], v[24:27], v[8:11]
  s_waitcnt vmcnt(6)
  s_cbranch_vccnz L185_x
  s_waitcnt vmcnt(4)
L185_x:
  buffer_load_dwordx4 v[168:171], v40, s[8:11], s36 offen offset:256 nt
  s_memrealtime s[0:1]
  v_mfma_f32_16x16x32_bf16 v[12:15], v[172:175], v[16:19], 0
  s_waitcnt vmcnt(6)
  s_cbranch_vccnz L186_x
  s_waitcnt vmcnt(4)
L186_x:
  buffer_load_dwordx4 v[172:175], v40, s[8:11], s37 offen offset:0 nt
  s_waitcnt lgkmcnt(0)
  s_lshl4_add_u32 s44, s0, s101
  s_sub_u32 s44, s44, s100
  s_add_u32 s100, s100, s87
  s_cmp_gt_i32 s44, 0
  s_cselect_b64 vcc, -1, 0
  s_cmp_lg_u32 s92, 0
  s_cbranch_scc1 L187_nopub
  v_mov_b32 v59, s0
  s_mov_b64 exec, 1
  buffer_store_dword v59, v58, s[4:7], 0 offen sc1
  s_mov_b64 exec, -1
  v_add_u32 v58, 2048, v58
L187_nopub:
  v_cndmask_b32 v2, v8, v10, s[16:17]
  v_cndmask_b32 v3, v9, v11, s[16:17]
  s_nop 1
  v_add_f32_dpp v2, v3, v2 quad_perm:[1,0,3,2] row_mask:0xf bank_mask:0xf
  v_cndmask_b32 v36, v36, v2, s[18:19]
  v_mfma_f32_16x16x32_bf16 v[12:15], v[176:179], v[20:23], v[12:15]
  s_waitcnt vmcnt(6)
  s_cbranch_vccnz L188_x
  s_waitcnt vmcnt(4)
L188_x:
  buffer_load_dwordx4 v[176:179], v40, s[8:11], s37 offen offset:128 nt
  v_mfma_f32_16x16x32_bf16 v[12:15], v[180:183], v[24:27], v[12:15]
  s_waitcnt vmcnt(6)
  s_cbranch_vccnz L189_x
  s_waitcnt vmcnt(4)
L189_x:
  buffer_load_dwordx4 v[180:183], v40, s[8:11], s37 offen offset:256 nt
  v_mfma_f32_16x16x32_bf16 v[8:11], v[184:187], v[16:19], 0
  s_waitcnt vmcnt(6)
  s_cbranch_vccnz L190_x
  s_waitcnt vmcnt(4)
L190_x:
  buffer_load_dwordx4 v[184:187], v40, s[8:11], s38 offen offset:0 nt
  s_memrealtime s[0:1]
  v_cndmask_b32 v2, v12, v14, s[16:17]
  v_cndmask_b32 v3, v13, v15, s[16:17]
  s_nop 1
  v_add_f32_dpp v2, v2, v3 quad_perm:[1,0,3,2] row_mask:0xf bank_mask:0xf
  v_cndmask_b32 v36, v36, v2, s[20:21]
  v_mfma_f32_16x16x32_bf16 v[8:11], v[188:191], v[20:23], v[8:11]
  s_waitcnt vmcnt(6)
  s_cbranch_vccnz L191_x
  s_waitcnt vmcnt(4)
L191_x:
  buffer_load_dwordx4 v[188:191], v40, s[8:11], s38 offen offset:128 nt
  s_waitcnt lgkmcnt(0)
  s_lshl4_add_u32 s44, s0, s101
  s_sub_u32 s44, s44, s100
  s_add_u32 s100, s100, s87
  s_cmp_gt_i32 s44, 0
  s_cselect_b64 vcc, -1, 0
  v_mfma_f32_16x16x32_bf16 v[8:11], v[192:195], v[24:27], v[8:11]
  s_waitcnt vmcnt(6)
  s_cbranch_vccnz L192_x
  s_waitcnt vmcnt(4)
L192_x:
  buffer_load_dwordx4 v[192:195], v40, s[8:11], s38 offen offset:256 nt
  v_mfma_f32_16x16x32_bf16 v[12:15], v[196:199], v[16:19], 0
  s_waitcnt vmcnt(6)
  s_cbranch_vccnz L193_x
  s_waitcnt vmcnt(4)
L193_x:
  buffer_load_dwordx4 v[196:199], v40, s[8:11], s39 offen offset:0 nt
  s_nop 0
  v_cndmask_b32 v2, v8, v10, s[16:17]
  v_cndmask_b32 v3, v9, v11, s[16:17]
  s_nop 1
  v_add_f32_dpp v2, v3, v2 quad_perm:[1,0,3,2] row_mask:0xf bank_mask:0xf
  v_cndmask_b32 v36, v36, v2, s[22:23]
  v_mfma_f32_16x16x32_bf16 v[12:15], v[200:203], v[20:23], v[12:15]
  s_waitcnt vmcnt(6)
  s_cbranch_vccnz L194_x
  s_waitcnt vmcnt(4)
L194_x:
  buffer_load_dwordx4 v[200:203], v40, s[8:11], s39 offen offset:128 nt
  s_memrealtime s[0:1]
  v_mfma_f32_16x16x32_bf16 v[12:15], v[204:207], v[24:27], v[12:15]
  s_waitcnt vmcnt(6)
  s_cbranch_vccnz L195_x
  s_waitcnt vmcnt(4)
L195_x:
  buffer_load_dwordx4 v[204:207], v40, s[8:11], s39 offen offset:256 nt
  s_waitcnt lgkmcnt(0)
  s_lshl4_add_u32 s44, s0, s101
  s_sub_u32 s44, s44, s100
  s_add_u32 s100, s100, s87
  s_cmp_gt_i32 s44, 0
  s_cselect_b64 vcc, -1, 0
  v_mfma_f32_16x16x32_bf16 v[8:11], v[208:211], v[16:19], 0
  s_waitcnt vmcnt(6)
  s_cbranch_vccnz L196_x
  s_waitcnt vmcnt(4)
L196_x:
  buffer_load_dwordx4 v[208:211], v40, s[8:11], s40 offen offset:0 nt
  v_cndmask_b32 v2, v12, v14, s[16:17]
  v_cndmask_b32 v3, v13, v15, s[16:17]
  s_nop 1
  v_add_f32_dpp v2, v2, v3 quad_perm:[1,0,3,2] row_mask:0xf bank_mask:0xf
  v_cndmask_b32 v36, v36, v2, s[24:25]
  v_mfma_f32_16x16x32_bf16 v[8:11], v[212:215], v[20:23], v[8:11]
  s_waitcnt vmcnt(6)
  s_cbranch_vccnz L197_x
  s_waitcnt vmcnt(4)
L197_x:
  buffer_load_dwordx4 v[212:215], v40, s[8:11], s40 offen offset:128 nt
  v_mfma_f32_16x16x32_bf16 v[8:11], v[216:219], v[24:27], v[8:11]
  s_waitcnt vmcnt(6)
  s_cbranch_vccnz L198_x
  s_waitcnt vmcnt(4)
L198_x:
  buffer_load_dwordx4 v[216:219], v40, s[8:11], s40 offen offset:256 nt
  s_memrealtime s[0:1]
  v_mfma_f32_16x16x32_bf16 v[12:15], v[220:223], v[16:19], 0
  s_waitcnt vmcnt(6)
  s_cbranch_vccnz L199_x
  s_waitcnt vmcnt(4)
L199_x:
  buffer_load_dwordx4 v[220:223], v40, s[8:11], s41 offen offset:0 nt
  s_waitcnt lgkmcnt(0)
  s_lshl4_add_u32 s44, s0, s101
  s_sub_u32 s44, s44, s100
  s_add_u32 s100, s100, s87
  s_cmp_gt_i32 s44, 0
  s_cselect_b64 vcc, -1, 0
  s_load_dword s70, s[64:65], 0
  s_load_dword s71, s[64:65], 128
  s_load_dword s72, s[64:65], 256
  s_load_dword s73, s[64:65], 384
  s_load_dword s74, s[64:65], 512
  s_load_dword s75, s[64:65], 640
  s_load_dword s76, s[64:65], 768
  s_load_dword s77, s[64:65], 896
  s_load_dword s78, s[64:65], 1024
  s_load_dword s79, s[64:65], 1152
  s_load_dword s80, s[64:65], 1280
  s_load_dword s81, s[64:65], 1408
  s_load_dword s82, s[64:65], 1536
  s_load_dword s83, s[64:65], 1664
  s_load_dword s84, s[64:65], 1792
  s_load_dword s85, s[64:65], 1920
  v_cndmask_b32 v2, v8, v10, s[16:17]
  v_cndmask_b32 v3, v9, v11, s[16:17]
  s_nop 1
  v_add_f32_dpp v2, v3, v2 quad_perm:[1,0,3,2] row_mask:0xf bank_mask:0xf
  v_cndmask_b32 v36, v36, v2, s[26:27]
  v_mfma_f32_16x16x32_bf16 v[12:15], v[224:227], v[20:23], v[12:15]
  s_waitcnt vmcnt(6)
  s_cbranch_vccnz L200_x
  s_waitcnt vmcnt(4)
L200_x:
  buffer_load_dwordx4 v[224:227], v40, s[8:11], s41 offen offset:128 nt
  v_mfma_f32_16x16x32_bf16 v[12:15], v[228:231], v[24:27], v[12:15]
  s_waitcnt vmcnt(6)
  s_cbranch_vccnz L201_x
  s_waitcnt vmcnt(4)
L201_x:
  buffer_load_dwordx4 v[228:231], v40, s[8:11], s41 offen offset:256 nt
  v_mfma_f32_16x16x32_bf16 v[8:11], v[232:235], v[16:19], 0
  s_waitcnt vmcnt(6)
  s_cbranch_vccnz L202_x
  s_waitcnt vmcnt(4)
L202_x:
  buffer_load_dwordx4 v[232:235], v40, s[8:11], s42 offen offset:0 nt
  s_memrealtime s[0:1]
  v_cndmask_b32 v2, v12, v14, s[16:17]
  v_cndmask_b32 v3, v13, v15, s[16:17]
  s_nop 1
  v_add_f32_dpp v2, v2, v3 quad_perm:[1,0,3,2] row_mask:0xf bank_mask:0xf
  v_cndmask_b32 v36, v36, v2, s[28:29]
  v_mfma_f32_16x16x32_bf16 v[8:11], v[236:239], v[20:23], v[8:11]
  s_waitcnt vmcnt(6)
  s_cbranch_vccnz L203_x
  s_waitcnt vmcnt(4)
L203_x:
  buffer_load_dwordx4 v[236:239], v40, s[8:11], s42 offen offset:128 nt
  s_waitcnt lgkmcnt(0)
  s_lshl4_add_u32 s44, s0, s101
  s_sub_u32 s44, s44, s100
  s_add_u32 s100, s100, s87
  s_cmp_gt_i32 s44, 0
  s_cselect_b64 vcc, -1, 0
  s_add_u32 s64, s64, 2048
  s_addc_u32 s65, s65, 0
  s_mov_b32 s45, 0
  s_sub_u32 s47, s44, s101
  s_max_i32 s47, s47, 0
  s_lshr_b32 s47, s47, 4
  s_add_u32 s47, s47, 90
  s_sub_u32 s47, s0, s47
  s_cmp_eq_u32 s70, -1
  s_cselect_b32 s70, s47, s70
  s_add_u32 s45, s45, s70
  s_cmp_eq_u32 s71, -1
  s_cselect_b32 s71, s47, s71
  s_add_u32 s45, s45, s71
  s_cmp_eq_u32 s72, -1
  s_cselect_b32 s72, s47, s72
  s_add_u32 s45, s45, s72
  s_cmp_eq_u32 s73, -1
  s_cselect_b32 s73, s47, s73
  s_add_u32 s45, s45, s73
  s_cmp_eq_u32 s74, -1
  s_cselect_b32 s74, s47, s74
  s_add_u32 s45, s45, s74
  s_cmp_eq_u32 s75, -1
  s_cselect_b32 s75, s47, s75
  s_add_u32 s45, s45, s75
  s_cmp_eq_u32 s76, -1
  s_cselect_b32 s76, s47, s76
  s_add_u32 s45, s45, s76
  s_cmp_eq_u32 s77, -1
  s_cselect_b32 s77, s47, s77
  s_add_u32 s45, s45, s77
  s_cmp_eq_u32 s78, -1
  s_cselect_b32 s78, s47, s78
  s_add_u32 s45, s45, s78
  s_cmp_eq_u32 s79, -1
  s_cselect_b32 s79, s47, s79
  s_add_u32 s45, s45, s79
  s_cmp_eq_u32 s80, -1
  s_cselect_b32 s80, s47, s80
  s_add_u32 s45, s45, s80
  s_cmp_eq_u32 s81, -1
  s_cselect_b32 s81, s47, s81
  s_add_u32 s45, s45, s81
  s_cmp_eq_u32 s82, -1
  s_cselect_b32 s82, s47, s82
  s_add_u32 s45, s45, s82
  s_cmp_eq_u32 s83, -1
  s_cselect_b32 s83, s47, s83
  s_add_u32 s45, s45, s83
  s_cmp_eq_u32 s84, -1
  s_cselect_b32 s84, s47, s84
  s_add_u32 s45, s45, s84
  s_cmp_eq_u32 s85, -1
  s_cselect_b32 s85, s47, s85
  s_add_u32 s45, s45, s85
  s_sub_u32 s44, s45, s86
  s_mov_b32 s86, s45
  s_mul_i32 s1, s87, 6
  s_sub_u32 s44, s44, s1
  s_min_i32 s44, s44, 640
  s_max_i32 s44, s44, -640
  s_mul_hi_i32 s44, s44, 357913941
  s_add_u32 s44, s44, s87
  s_sub_u32 s98, s98, 1
  s_cselect_b32 s87, s44, s87
  s_cselect_b32 s98, 0, s98
  s_mul_i32 s44, s87, 5
  s_add_u32 s100, s45, s44
  v_mfma_f32_16x16x32_bf16 v[8:11], v[240:243], v[24:27], v[8:11]
  s_waitcnt vmcnt(6)
  s_cbranch_vccnz L204_x
  s_waitcnt vmcnt(4)
L204_x:
  buffer_load_dwordx4 v[240:243], v40, s[8:11], s42 offen offset:256 nt
  v_mfma_f32_16x16x32_bf16 v[12:15], v[244:247], v[16:19], 0
  ds_read_b128 v[16:19], v51 offset:256
  s_waitcnt vmcnt(6)
  s_cbranch_vccnz L205_x
  s_waitcnt vmcnt(4)
L205_x:
  buffer_load_dwordx4 v[244:247], v41, s[8:11], s43 offen offset:0 nt
  v_cndmask_b32 v2, v8, v10, s[16:17]
  v_cndmask_b32 v3, v9, v11, s[16:17]
  s_nop 1
  v_add_f32_dpp v2, v3, v2 quad_perm:[1,0,3,2] row_mask:0xf bank_mask:0xf
  v_cndmask_b32 v36, v36, v2, s[30:31]
  v_mfma_f32_16x16x32_bf16 v[12:15], v[248:251], v[20:23], v[12:15]
  ds_read_b128 v[20:23], v51 offset:1280
  s_waitcnt vmcnt(6)
  s_cbranch_vccnz L206_x
  s_waitcnt vmcnt(4)
L206_x:
  buffer_load_dwordx4 v[248:251], v41, s[8:11], s43 offen offset:128 nt
  s_memrealtime s[0:1]
  v_mfma_f32_16x16x32_bf16 v[12:15], v[252:255], v[24:27], v[12:15]
  ds_read_b128 v[24:27], v51 offset:2304
  s_waitcnt vmcnt(6)
  s_cbranch_vccnz L207_x
  s_waitcnt vmcnt(4)
L207_x:
  buffer_load_dwordx4 v[252:255], v41, s[8:11], s43 offen offset:256 nt
  s_and_b32 s46, s97, 7
  s_lshr_b32 s97, s97, 4
  s_mul_i32 s46, s46, 25165824
  s_add_u32 s8, s14, s46
  s_addc_u32 s9, s15, 0
  s_waitcnt lgkmcnt(0)
  s_lshl4_add_u32 s44, s0, s101
  s_sub_u32 s44, s44, s100
  s_add_u32 s100, s100, s87
  s_cmp_gt_i32 s44, 0
  s_cselect_b64 vcc, -1, 0
  v_cndmask_b32 v2, v12, v14, s[16:17]
  v_cndmask_b32 v3, v13, v15, s[16:17]
  s_nop 1
  v_add_f32_dpp v2, v2, v3 quad_perm:[1,0,3,2] row_mask:0xf bank_mask:0xf
  v_cndmask_b32 v36, v36, v2, s[32:33]
  v_cvt_pk_bf16_f32 v36, v36, v36
  v_lshlrev_b32 v36, 16, v36
  v_mul_f32 v36, 0x3d93cd3a, v36
  v_cvt_pk_bf16_f32 v36, v36, v36
  v_lshlrev_b32 v35, 16, v36
  v_add_u32 v51, 256, v51
  s_add_u32 s99, s99, 1
  s_cmp_lt_u32 s99, 4
  s_cbranch_scc1 L_kloop
  v_mov_b32 v8, v35
  v_mov_b32 v9, v34
  v_mov_b32 v10, v33
  v_mov_b32 v11, v31
  v_mov_b32 v12, v30
  v_mov_b32 v13, v29
  v_mov_b32 v14, v32
  v_mov_b32 v15, v28
  v_permlane32_swap_b32 v8, v10
  v_permlane32_swap_b32 v9, v11
  v_permlane32_swap_b32 v12, v14
  v_permlane32_swap_b32 v13, v15
  v_max_f32 v8, v8, v10
  v_max_f32 v9, v9, v11
  v_max_f32 v12, v12, v14
  v_max_f32 v13, v13, v15
  v_permlane16_swap_b32 v8, v9
  s_nop 0
  v_permlane16_swap_b32 v12, v13
  v_max_f32 v46, v8, v9
  v_max_f32 v48, v12, v13
  s_nop 0
  v_max_f32_dpp v46, v46, v46 quad_perm:[1,0,3,2] row_mask:0xf bank_mask:0xf
  v_max_f32_dpp v48, v48, v48 quad_perm:[1,0,3,2] row_mask:0xf bank_mask:0xf
  s_nop 0
  v_max_f32_dpp v46, v46, v46 quad_perm:[2,3,0,1] row_mask:0xf bank_mask:0xf
  v_max_f32_dpp v48, v48, v48 quad_perm:[2,3,0,1] row_mask:0xf bank_mask:0xf
  s_nop 0
  v_max_f32_dpp v46, v46, v46 row_half_mirror row_mask:0xf bank_mask:0xf
  v_max_f32_dpp v48, v48, v48 row_half_mirror row_mask:0xf bank_mask:0xf
  s_nop 0
  v_max_f32_dpp v46, v46, v46 row_mirror row_mask:0xf bank_mask:0xf
  v_max_f32_dpp v48, v48, v48 row_mirror row_mask:0xf bank_mask:0xf
  v_readlane_b32 s70, v46, 0
  v_readlane_b32 s71, v46, 16
  v_readlane_b32 s72, v46, 32
  v_readlane_b32 s73, v46, 48
  v_readlane_b32 s74, v48, 0
  v_readlane_b32 s75, v48, 16
  v_readlane_b32 s76, v48, 32
  v_readlane_b32 s77, v48, 48
  v_subrev_f32 v8, s70, v35
  v_subrev_f32 v9, s71, v34
  v_subrev_f32 v10, s72, v33
  v_subrev_f32 v11, s73, v31
  v_subrev_f32 v12, s74, v30
  v_subrev_f32 v13, s75, v29
  v_subrev_f32 v14, s76, v32
  v_subrev_f32 v15, s77, v28
  v_mul_f32 v8, 0x3fb8aa3b, v8
  v_mul_f32 v9, 0x3fb8aa3b, v9
  v_mul_f32 v10, 0x3fb8aa3b, v10
  v_mul_f32 v11, 0x3fb8aa3b, v11
  v_mul_f32 v12, 0x3fb8aa3b, v12
  v_mul_f32 v13, 0x3fb8aa3b, v13
  v_mul_f32 v14, 0x3fb8aa3b, v14
  v_mul_f32 v15, 0x3fb8aa3b, v15
  v_exp_f32 v8, v8
  v_exp_f32 v9, v9
  v_exp_f32 v10, v10
  v_exp_f32 v11, v11
  v_exp_f32 v12, v12
  v_exp_f32 v13, v13
  v_exp_f32 v14, v14
  v_exp_f32 v15, v15
  v_cvt_pk_bf16_f32 v28, v8, v8
  v_cvt_pk_bf16_f32 v29, v9, v9
  v_cvt_pk_bf16_f32 v30, v10, v10
  v_cvt_pk_bf16_f32 v31, v11, v11
  v_cvt_pk_bf16_f32 v32, v12, v12
  v_cvt_pk_bf16_f32 v33, v13, v13
  v_cvt_pk_bf16_f32 v34, v14, v14
  v_cvt_pk_bf16_f32 v35, v15, v15
  v_mov_b32 v61, v15
  v_permlane32_swap_b32 v8, v10
  v_permlane32_swap_b32 v9, v11
  v_permlane32_swap_b32 v12, v14
  v_permlane32_swap_b32 v13, v15
  v_add_f32 v8, v8, v10
  v_add_f32 v9, v9, v11
  v_add_f32 v12, v12, v14
  v_add_f32 v13, v13, v15
  v_permlane16_swap_b32 v8, v9
  s_nop 0
  v_permlane16_swap_b32 v12, v13
  v_add_f32 v47, v8, v9
  v_add_f32 v49, v12, v13
  s_nop 0
  v_add_f32_dpp v47, v47, v47 quad_perm:[1,0,3,2] row_mask:0xf bank_mask:0xf
  v_add_f32_dpp v49, v49, v49 quad_perm:[1,0,3,2] row_mask:0xf bank_mask:0xf
  s_nop 0
  v_add_f32_dpp v47, v47, v47 quad_perm:[2,3,0,1] row_mask:0xf bank_mask:0xf
  v_add_f32_dpp v49, v49, v49 quad_perm:[2,3,0,1] row_mask:0xf bank_mask:0xf
  s_nop 0
  v_add_f32_dpp v47, v47, v47 row_half_mirror row_mask:0xf bank_mask:0xf
  v_add_f32_dpp v49, v49, v49 row_half_mirror row_mask:0xf bank_mask:0xf
  s_nop 0
  v_add_f32_dpp v47, v47, v47 row_mirror row_mask:0xf bank_mask:0xf
  v_add_f32_dpp v49, v49, v49 row_mirror row_mask:0xf bank_mask:0xf
  s_mov_b32 exec_lo, 0x00010001
  s_mov_b32 exec_hi, 0x00010001
  ds_write_b64 v52, v[46:47]
  ds_write_b64 v52, v[48:49] offset:128
  s_mov_b64 exec, 1
  ds_add_u32 v63, v55 offset:32
  s_mov_b64 exec, -1
  s_waitcnt lgkmcnt(0)
  v_mov_b32 v6, 0
  v_mov_b32 v37, 0
  s_nop 0
  v_mov_b32_dpp v6, v28 row_newbcast:0 row_mask:0xf bank_mask:0x3
  v_mov_b32_dpp v37, v28 row_newbcast:8 row_mask:0xf bank_mask:0xc
  v_or_b32 v5, v6, v37
  v_and_b32 v8, v5, v42
  v_and_b32 v9, v5, v43
  v_and_b32 v10, v5, v44
  v_and_b32 v11, v5, v45
  s_nop 1
  v_mfma_f32_16x16x32_bf16 v[16:19], v[64:67], v[8:11], 0
  v_mfma_f32_16x16x32_bf16 v[20:23], v[68:71], v[8:11], 0
  s_waitcnt vmcnt(6)
  s_cbranch_vccnz L208_x
  s_waitcnt vmcnt(4)
L208_x:
  buffer_load_dwordx4 v[64:67], v40, s[8:11], s36 offen offset:0 nt
  v_mfma_f32_16x16x32_bf16 v[24:27], v[72:75], v[8:11], 0
  v_mov_b32_dpp v6, v28 row_newbcast:1 row_mask:0xf bank_mask:0x3
  v_mov_b32_dpp v37, v28 row_newbcast:9 row_mask:0xf bank_mask:0xc
  v_or_b32 v5, v6, v37
  v_and_b32 v12, v5, v42
  v_and_b32 v13, v5, v43
  v_and_b32 v14, v5, v44
  v_and_b32 v15, v5, v45
  s_nop 1
  v_mfma_f32_16x16x32_bf16 v[16:19], v[76:79], v[12:15], v[16:19]
  s_waitcnt vmcnt(6)
  s_cbranch_vccnz L209_x
  s_waitcnt vmcnt(4)
L209_x:
  buffer_load_dwordx4 v[68:71], v40, s[8:11], s36 offen offset:128 nt
  v_mfma_f32_16x16x32_bf16 v[20:23], v[80:83], v[12:15], v[20:23]
  v_mfma_f32_16x16x32_bf16 v[24:27], v[84:87], v[12:15], v[24:27]
  s_waitcnt vmcnt(6)
  s_cbranch_vccnz L210_x
  s_waitcnt vmcnt(4)
L210_x:
  buffer_load_dwordx4 v[72:75], v40, s[8:11], s36 offen offset:256 nt
  s_memrealtime s[0:1]
  v_mov_b32_dpp v6, v28 row_newbcast:2 row_mask:0xf bank_mask:0x3
  v_mov_b32_dpp v37, v28 row_newbcast:10 row_mask:0xf bank_mask:0xc
  v_or_b32 v5, v6, v37
  v_and_b32 v8, v5, v42
  v_and_b32 v9, v5, v43
  v_and_b32 v10, v5, v44
  v_and_b32 v11, v5, v45
  s_nop 1
  v_mfma_f32_16x16x32_bf16 v[16:19], v[88:91], v[8:11], v[16:19]
  v_mfma_f32_16x16x32_bf16 v[20:23], v[92:95], v[8:11], v[20:23]
  s_waitcnt vmcnt(6)
  s_cbranch_vccnz L211_x
  s_waitcnt vmcnt(4)
L211_x:
  buffer_load_dwordx4 v[76:79], v40, s[8:11], s37 offen offset:0 nt
  s_waitcnt lgkmcnt(0)
  s_lshl4_add_u32 s44, s0, s101
  s_sub_u32 s44, s44, s100
  s_add_u32 s100, s100, s87
  s_cmp_gt_i32 s44, 0
  s_cselect_b64 vcc, -1, 0
  s_cmp_lg_u32 s92, 0
  s_cbranch_scc1 L212_nopub
  v_mov_b32 v59, s0
  s_mov_b64 exec, 1
  buffer_store_dword v59, v58, s[4:7], 0 offen sc1
  s_mov_b64 exec, -1
  v_add_u32 v58, 2048, v58
L212_nopub:
  v_mfma_f32_16x16x32_bf16 v[24:27], v[96:99], v[8:11], v[24:27]
  v_mov_b32_dpp v6, v28 row_newbcast:3 row_mask:0xf bank_mask:0x3
  v_mov_b32_dpp v37, v28 row_newbcast:11 row_mask:0xf bank_mask:0xc
  v_or_b32 v5, v6, v37
  v_and_b32 v12, v5, v42
  v_and_b32 v13, v5, v43
  v_and_b32 v14, v5, v44
  v_and_b32 v15, v5, v45
  s_nop 1
  v_mfma_f32_16x16x32_bf16 v[16:19], v[100:103], v[12:15], v[16:19]
  s_waitcnt vmcnt(6)
  s_cbranch_vccnz L213_x
  s_waitcnt vmcnt(4)
L213_x:
  buffer_load_dwordx4 v[80:83], v40, s[8:11], s37 offen offset:128 nt
  v_mfma_f32_16x16x32_bf16 v[20:23], v[104:107], v[12:15], v[20:23]
  v_mfma_f32_16x16x32_bf16 v[24:27], v[108:111], v[12:15], v[24:27]
  s_waitcnt vmcnt(6)
  s_cbranch_vccnz L214_x
  s_waitcnt vmcnt(4)
L214_x:
  buffer_load_dwordx4 v[84:87], v40, s[8:11], s37 offen offset:256 nt
  v_mov_b32_dpp v6, v28 row_newbcast:4 row_mask:0xf bank_mask:0x3
  v_mov_b32_dpp v37, v28 row_newbcast:12 row_mask:0xf bank_mask:0xc
  v_or_b32 v5, v6, v37
  v_and_b32 v8, v5, v42
  v_and_b32 v9, v5, v43
  v_and_b32 v10, v5, v44
  v_and_b32 v11, v5, v45
  s_nop 1
  v_mfma_f32_16x16x32_bf16 v[16:19], v[112:115], v[8:11], v[16:19]
  v_mfma_f32_16x16x32_bf16 v[20:23], v[116:119], v[8:11], v[20:23]
  s_waitcnt vmcnt(6)
  s_cbranch_vccnz L215_x
  s_waitcnt vmcnt(4)
L215_x:
  buffer_load_dwordx4 v[88:91], v40, s[8:11], s38 offen offset:0 nt
  s_memrealtime s[0:1]
  v_mfma_f32_16x16x32_bf16 v[24:27], v[120:123], v[8:11], v[24:27]
  v_mov_b32_dpp v6, v28 row_newbcast:5 row_mask:0xf bank_mask:0x3
  v_mov_b32_dpp v37, v28 row_newbcast:13 row_mask:0xf bank_mask:0xc
  v_or_b32 v5, v6, v37
  v_and_b32 v12, v5, v42
  v_and_b32 v13, v5, v43
  v_and_b32 v14, v5, v44
  v_and_b32 v15, v5, v45
  s_nop 1
  v_mfma_f32_16x16x32_bf16 v[16:19], v[124:127], v[12:15], v[16:19]
  s_waitcnt vmcnt(6)
  s_cbranch_vccnz L216_x
  s_waitcnt vmcnt(4)
L216_x:
  buffer_load_dwordx4 v[92:95], v40, s[8:11], s38 offen offset:128 nt
  s_waitcnt lgkmcnt(0)
  s_lshl4_add_u32 s44, s0, s101
  s_sub_u32 s44, s44, s100
  s_add_u32 s100, s100, s87
  s_cmp_gt_i32 s44, 0
  s_cselect_b64 vcc, -1, 0
  v_mfma_f32_16x16x32_bf16 v[20:23], v[128:131], v[12:15], v[20:23]
  v_mfma_f32_16x16x32_bf16 v[24:27], v[132:135], v[12:15], v[24:27]
  s_waitcnt vmcnt(6)
  s_cbranch_vccnz L217_x
  s_waitcnt vmcnt(4)
L217_x:
  buffer_load_dwordx4 v[96:99], v40, s[8:11], s38 offen offset:256 nt
  v_mov_b32_dpp v6, v28 row_newbcast:6 row_mask:0xf bank_mask:0x3
  v_mov_b32_dpp v37, v28 row_newbcast:14 row_mask:0xf bank_mask:0xc
  v_or_b32 v5, v6, v37
  v_and_b32 v8, v5, v42
  v_and_b32 v9, v5, v43
  v_and_b32 v10, v5, v44
  v_and_b32 v11, v5, v45
  s_nop 1
  v_mfma_f32_16x16x32_bf16 v[16:19], v[136:139], v[8:11], v[16:19]
  v_mfma_f32_16x16x32_bf16 v[20:23], v[140:143], v[8:11], v[20:23]
  s_waitcnt vmcnt(6)
  s_cbranch_vccnz L218_x
  s_waitcnt vmcnt(4)
L218_x:
  buffer_load_dwordx4 v[100:103], v40, s[8:11], s39 offen offset:0 nt
  v_mfma_f32_16x16x32_bf16 v[24:27], v[144:147], v[8:11], v[24:27]
  v_mov_b32_dpp v6, v28 row_newbcast:7 row_mask:0xf bank_mask:0x3
  v_mov_b32_dpp v37, v28 row_newbcast:15 row_mask:0xf bank_mask:0xc
  v_or_b32 v5, v6, v37
  v_and_b32 v12, v5, v42
  v_and_b32 v13, v5, v43
  v_and_b32 v14, v5, v44
  v_and_b32 v15, v5, v45
  s_nop 1
  v_mfma_f32_16x16x32_bf16 v[16:19], v[148:151], v[12:15], v[16:19]
  s_waitcnt vmcnt(6)
  s_cbranch_vccnz L219_x
  s_waitcnt vmcnt(4)
L219_x:
  buffer_load_dwordx4 v[104:107], v40, s[8:11], s39 offen offset:128 nt
  s_memrealtime s[0:1]
  v_mfma_f32_16x16x32_bf16 v[20:23], v[152:155], v[12:15], v[20:23]
  v_mfma_f32_16x16x32_bf16 v[24:27], v[156:159], v[12:15], v[24:27]
  s_waitcnt vmcnt(6)
  s_cbranch_vccnz L220_x
  s_waitcnt vmcnt(4)
L220_x:
  buffer_load_dwordx4 v[108:111], v40, s[8:11], s39 offen offset:256 nt
  s_waitcnt lgkmcnt(0)
  s_lshl4_add_u32 s44, s0, s101
  s_sub_u32 s44, s44, s100
  s_add_u32 s100, s100, s87
  s_cmp_gt_i32 s44, 0
  s_cselect_b64 vcc, -1, 0
  s_mov_b64 exec, s[94:95]
  ds_write_b128 v62, v[16:19] offset:0
  ds_write_b128 v62, v[20:23] offset:256
  ds_write_b128 v62, v[24:27] offset:512
  s_mov_b64 exec, 1
  ds_add_u32 v63, v60 offset:36
  s_mov_b64 exec, -1
  v_add_u32 v62, 1536, v62
  v_lshlrev_b32 v60, 4, v60
  v_mov_b32_dpp v6, v29 row_newbcast:0 row_mask:0xf bank_mask:0x3
  v_mov_b32_dpp v37, v29 row_newbcast:8 row_mask:0xf bank_mask:0xc
  v_or_b32 v5, v6, v37
  v_and_b32 v8, v5, v42
  v_and_b32 v9, v5, v43
  v_and_b32 v10, v5, v44
  v_and_b32 v11, v5, v45
  s_nop 1
  v_mfma_f32_16x16x32_bf16 v[16:19], v[160:163], v[8:11], 0
  v_mfma_f32_16x16x32_bf16 v[20:23], v[164:167], v[8:11], 0
  s_waitcnt vmcnt(6)
  s_cbranch_vccnz L221_x
  s_waitcnt vmcnt(4)
L221_x:
  buffer_load_dwordx4 v[112:115], v40, s[8:11], s40 offen offset:0 nt
  v_mfma_f32_16x16x32_bf16 v[24:27], v[168:171], v[8:11], 0
  v_mov_b32_dpp v6, v29 row_newbcast:1 row_mask:0xf bank_mask:0x3
  v_mov_b32_dpp v37, v29 row_newbcast:9 row_mask:0xf bank_mask:0xc
  v_or_b32 v5, v6, v37
  v_and_b32 v12, v5, v42
  v_and_b32 v13, v5, v43
  v_and_b32 v14, v5, v44
  v_and_b32 v15, v5, v45
  s_nop 1
  v_mfma_f32_16x16x32_bf16 v[16:19], v[172:175], v[12:15], v[16:19]
  s_waitcnt vmcnt(6)
  s_cbranch_vccnz L222_x
  s_waitcnt vmcnt(4)
L222_x:
  buffer_load_dwordx4 v[116:119], v40, s[8:11], s40 offen offset:128 nt
  v_mfma_f32_16x16x32_bf16 v[20:23], v[176:179], v[12:15], v[20:23]
  v_mfma_f32_16x16x32_bf16 v[24:27], v[180:183], v[12:15], v[24:27]
  s_waitcnt vmcnt(6)
  s_cbranch_vccnz L223_x
  s_waitcnt vmcnt(4)
L223_x:
  buffer_load_dwordx4 v[120:123], v40, s[8:11], s40 offen offset:256 nt
  s_memrealtime s[0:1]
  v_mov_b32_dpp v6, v29 row_newbcast:2 row_mask:0xf bank_mask:0x3
  v_mov_b32_dpp v37, v29 row_newbcast:10 row_mask:0xf bank_mask:0xc
  v_or_b32 v5, v6, v37
  v_and_b32 v8, v5, v42
  v_and_b32 v9, v5, v43
  v_and_b32 v10, v5, v44
  v_and_b32 v11, v5, v45
  s_nop 1
  v_mfma_f32_16x16x32_bf16 v[16:19], v[184:187], v[8:11], v[16:19]
  v_mfma_f32_16x16x32_bf16 v[20:23], v[188:191], v[8:11], v[20:23]
  s_waitcnt vmcnt(6)
  s_cbranch_vccnz L224_x
  s_waitcnt vmcnt(4)
L224_x:
  buffer_load_dwordx4 v[124:127], v40, s[8:11], s41 offen offset:0 nt
  s_waitcnt lgkmcnt(0)
  s_lshl4_add_u32 s44, s0, s101
  s_sub_u32 s44, s44, s100
  s_add_u32 s100, s100, s87
  s_cmp_gt_i32 s44, 0
  s_cselect_b64 vcc, -1, 0
  s_load_dword s70, s[64:65], 0
  s_load_dword s71, s[64:65], 128
  s_load_dword s72, s[64:65], 256
  s_load_dword s73, s[64:65], 384
  s_load_dword s74, s[64:65], 512
  s_load_dword s75, s[64:65], 640
  s_load_dword s76, s[64:65], 768
  s_load_dword s77, s[64:65], 896
  s_load_dword s78, s[64:65], 1024
  s_load_dword s79, s[64:65], 1152
  s_load_dword s80, s[64:65], 1280
  s_load_dword s81, s[64:65], 1408
  s_load_dword s82, s[64:65], 1536
  s_load_dword s83, s[64:65], 1664
  s_load_dword s84, s[64:65], 1792
  s_load_dword s85, s[64:65], 1920
  v_mfma_f32_16x16x32_bf16 v[24:27], v[192:195], v[8:11], v[24:27]
  v_mov_b32_dpp v6, v29 row_newbcast:3 row_mask:0xf bank_mask:0x3
  v_mov_b32_dpp v37, v29 row_newbcast:11 row_mask:0xf bank_mask:0xc
  v_or_b32 v5, v6, v37
  v_and_b32 v12, v5, v42
  v_and_b32 v13, v5, v43
  v_and_b32 v14, v5, v44
  v_and_b32 v15, v5, v45
  s_nop 1
  v_mfma_f32_16x16x32_bf16 v[16:19], v[196:199], v[12:15], v[16:19]
  s_waitcnt vmcnt(6)
  s_cbranch_vccnz L225_x
  s_waitcnt vmcnt(4)
L225_x:
  buffer_load_dwordx4 v[128:131], v40, s[8:11], s41 offen offset:128 nt
  v_mfma_f32_16x16x32_bf16 v[20:23], v[200:203], v[12:15], v[20:23]
  v_mfma_f32_16x16x32_bf16 v[24:27], v[204:207], v[12:15], v[24:27]
  s_waitcnt vmcnt(6)
  s_cbranch_vccnz L226_x
  s_waitcnt vmcnt(4)
L226_x:
  buffer_load_dwordx4 v[132:135], v40, s[8:11], s41 offen offset:256 nt
  v_mov_b32_dpp v6, v29 row_newbcast:4 row_mask:0xf bank_mask:0x3
  v_mov_b32_dpp v37, v29 row_newbcast:12 row_mask:0xf bank_mask:0xc
  v_or_b32 v5, v6, v37
  v_and_b32 v8, v5, v42
  v_and_b32 v9, v5, v43
  v_and_b32 v10, v5, v44
  v_and_b32 v11, v5, v45
  s_nop 1
  v_mfma_f32_16x16x32_bf16 v[16:19], v[208:211], v[8:11], v[16:19]
  v_mfma_f32_16x16x32_bf16 v[20:23], v[212:215], v[8:11], v[20:23]
  s_waitcnt vmcnt(6)
  s_cbranch_vccnz L227_x
  s_waitcnt vmcnt(4)
L227_x:
  buffer_load_dwordx4 v[136:139], v40, s[8:11], s42 offen offset:0 nt
  s_memrealtime s[0:1]
  v_mfma_f32_16x16x32_bf16 v[24:27], v[216:219], v[8:11], v[24:27]
  v_mov_b32_dpp v6, v29 row_newbcast:5 row_mask:0xf bank_mask:0x3
  v_mov_b32_dpp v37, v29 row_newbcast:13 row_mask:0xf bank_mask:0xc
  v_or_b32 v5, v6, v37
  v_and_b32 v12, v5, v42
  v_and_b32 v13, v5, v43
  v_and_b32 v14, v5, v44
  v_and_b32 v15, v5, v45
  s_nop 1
  v_mfma_f32_16x16x32_bf16 v[16:19], v[220:223], v[12:15], v[16:19]
  s_waitcnt vmcnt(6)
  s_cbranch_vccnz L228_x
  s_waitcnt vmcnt(4)
L228_x:
  buffer_load_dwordx4 v[140:143], v40, s[8:11], s42 offen offset:128 nt
  s_waitcnt lgkmcnt(0)
  s_lshl4_add_u32 s44, s0, s101
  s_sub_u32 s44, s44, s100
  s_add_u32 s100, s100, s87
  s_cmp_gt_i32 s44, 0
  s_cselect_b64 vcc, -1, 0
  s_add_u32 s64, s64, 2048
  s_addc_u32 s65, s65, 0
  s_mov_b32 s45, 0
  s_sub_u32 s47, s44, s101
  s_max_i32 s47, s47, 0
  s_lshr_b32 s47, s47, 4
  s_add_u32 s47, s47, 90
  s_sub_u32 s47, s0, s47
  s_cmp_eq_u32 s70, -1
  s_cselect_b32 s70, s47, s70
  s_add_u32 s45, s45, s70
  s_cmp_eq_u32 s71, -1
  s_cselect_b32 s71, s47, s71
  s_add_u32 s45, s45, s71
  s_cmp_eq_u32 s72, -1
  s_cselect_b32 s72, s47, s72
  s_add_u32 s45, s45, s72
  s_cmp_eq_u32 s73, -1
  s_cselect_b32 s73, s47, s73
  s_add_u32 s45, s45, s73
  s_cmp_eq_u32 s74, -1
  s_cselect_b32 s74, s47, s74
  s_add_u32 s45, s45, s74
  s_cmp_eq_u32 s75, -1
  s_cselect_b32 s75, s47, s75
  s_add_u32 s45, s45, s75
  s_cmp_eq_u32 s76, -1
  s_cselect_b32 s76, s47, s76
  s_add_u32 s45, s45, s76
  s_cmp_eq_u32 s77, -1
  s_cselect_b32 s77, s47, s77
  s_add_u32 s45, s45, s77
  s_cmp_eq_u32 s78, -1
  s_cselect_b32 s78, s47, s78
  s_add_u32 s45, s45, s78
  s_cmp_eq_u32 s79, -1
  s_cselect_b32 s79, s47, s79
  s_add_u32 s45, s45, s79
  s_cmp_eq_u32 s80, -1
  s_cselect_b32 s80, s47, s80
  s_add_u32 s45, s45, s80
  s_cmp_eq_u32 s81, -1
  s_cselect_b32 s81, s47, s81
  s_add_u32 s45, s45, s81
  s_cmp_eq_u32 s82, -1
  s_cselect_b32 s82, s47, s82
  s_add_u32 s45, s45, s82
  s_cmp_eq_u32 s83, -1
  s_cselect_b32 s83, s47, s83
  s_add_u32 s45, s45, s83
  s_cmp_eq_u32 s84, -1
  s_cselect_b32 s84, s47, s84
  s_add_u32 s45, s45, s84
  s_cmp_eq_u32 s85, -1
  s_cselect_b32 s85, s47, s85
  s_add_u32 s45, s45, s85
  s_sub_u32 s44, s45, s86
  s_mov_b32 s86, s45
  s_mul_i32 s1, s87, 6
  s_sub_u32 s44, s44, s1
  s_min_i32 s44, s44, 640
  s_max_i32 s44, s44, -640
  s_mul_hi_i32 s44, s44, 357913941
  s_add_u32 s44, s44, s87
  s_sub_u32 s98, s98, 1
  s_cselect_b32 s87, s44, s87
  s_cselect_b32 s98, 0, s98
  s_mul_i32 s44, s87, 5
  s_add_u32 s100, s45, s44
  v_mfma_f32_16x16x32_bf16 v[20:23], v[224:227], v[12:15], v[20:23]
  v_mfma_f32_16x16x32_bf16 v[24:27], v[228:231], v[12:15], v[24:27]
  s_waitcnt vmcnt(6)
  s_cbranch_vccnz L229_x
  s_waitcnt vmcnt(4)
L229_x:
  buffer_load_dwordx4 v[144:147], v40, s[8:11], s42 offen offset:256 nt
  v_mov_b32_dpp v6, v29 row_newbcast:6 row_mask:0xf bank_mask:0x3
  v_mov_b32_dpp v37, v29 row_newbcast:14 row_mask:0xf bank_mask:0xc
  v_or_b32 v5, v6, v37
  v_and_b32 v8, v5, v42
  v_and_b32 v9, v5, v43
  v_and_b32 v10, v5, v44
  v_and_b32 v11, v5, v45
  s_nop 1
  v_mfma_f32_16x16x32_bf16 v[16:19], v[232:235], v[8:11], v[16:19]
  v_mfma_f32_16x16x32_bf16 v[20:23], v[236:239], v[8:11], v[20:23]
  s_waitcnt vmcnt(6)
  s_cbranch_vccnz L230_x
  s_waitcnt vmcnt(4)
L230_x:
  buffer_load_dwordx4 v[148:151], v41, s[8:11], s43 offen offset:0 nt
  v_mfma_f32_16x16x32_bf16 v[24:27], v[240:243], v[8:11], v[24:27]
  v_mov_b32_dpp v6, v29 row_newbcast:7 row_mask:0xf bank_mask:0x3
  v_mov_b32_dpp v37, v29 row_newbcast:15 row_mask:0xf bank_mask:0xc
  v_or_b32 v5, v6, v37
  v_and_b32 v12, v5, v42
  v_and_b32 v13, v5, v43
  v_and_b32 v14, v5, v44
  v_and_b32 v15, v5, v45
  s_nop 1
  v_mfma_f32_16x16x32_bf16 v[16:19], v[244:247], v[12:15], v[16:19]
  s_waitcnt vmcnt(6)
  s_cbranch_vccnz L231_x
  s_waitcnt vmcnt(4)
L231_x:
  buffer_load_dwordx4 v[152:155], v41, s[8:11], s43 offen offset:128 nt
  s_memrealtime s[0:1]
  v_mfma_f32_16x16x32_bf16 v[20:23], v[248:251], v[12:15], v[20:23]
  v_mfma_f32_16x16x32_bf16 v[24:27], v[252:255], v[12:15], v[24:27]
  s_waitcnt vmcnt(6)
  s_cbranch_vccnz L232_x
  s_waitcnt vmcnt(4)
L232_x:
  buffer_load_dwordx4 v[156:159], v41, s[8:11], s43 offen offset:256 nt
  s_and_b32 s46, s97, 7
  s_lshr_b32 s97, s97, 4
  s_mul_i32 s46, s46, 25165824
  s_add_u32 s8, s14, s46
  s_addc_u32 s9, s15, 0
  s_waitcnt lgkmcnt(0)
  s_lshl4_add_u32 s44, s0, s101
  s_sub_u32 s44, s44, s100
  s_add_u32 s100, s100, s87
  s_cmp_gt_i32 s44, 0
  s_cselect_b64 vcc, -1, 0
  s_mov_b64 exec, s[94:95]
  ds_write_b128 v62, v[16:19] offset:0
  ds_write_b128 v62, v[20:23] offset:256
  ds_write_b128 v62, v[24:27] offset:512
  s_mov_b64 exec, 1
  ds_add_u32 v63, v60 offset:36
  s_mov_b64 exec, -1
  v_add_u32 v62, 1536, v62
  v_lshlrev_b32 v60, 4, v60
  v_mov_b32_dpp v6, v30 row_newbcast:0 row_mask:0xf bank_mask:0x3
  v_mov_b32_dpp v37, v30 row_newbcast:8 row_mask:0xf bank_mask:0xc
  v_or_b32 v5, v6, v37
  v_and_b32 v8, v5, v42
  v_and_b32 v9, v5, v43
  v_and_b32 v10, v5, v44
  v_and_b32 v11, v5, v45
  s_nop 1
  v_mfma_f32_16x16x32_bf16 v[16:19], v[64:67], v[8:11], 0
  v_mfma_f32_16x16x32_bf16 v[20:23], v[68:71], v[8:11], 0
  s_waitcnt vmcnt(6)
  s_cbranch_vccnz L233_x
  s_waitcnt vmcnt(4)
L233_x:
  buffer_load_dwordx4 v[160:163], v40, s[8:11], s36 offen offset:0 nt
  v_mfma_f32_16x16x32_bf16 v[24:27], v[72:75], v[8:11], 0
  v_mov_b32_dpp v6, v30 row_newbcast:1 row_mask:0xf bank_mask:0x3
  v_mov_b32_dpp v37, v30 row_newbcast:9 row_mask:0xf bank_mask:0xc
  v_or_b32 v5, v6, v37
  v_and_b32 v12, v5, v42
  v_and_b32 v13, v5, v43
  v_and_b32 v14, v5, v44
  v_and_b32 v15, v5, v45
  s_nop 1
  v_mfma_f32_16x16x32_bf16 v[16:19], v[76:79], v[12:15], v[16:19]
  s_waitcnt vmcnt(6)
  s_cbranch_vccnz L234_x
  s_waitcnt vmcnt(4)
L234_x:
  buffer_load_dwordx4 v[164:167], v40, s[8:11], s36 offen offset:128 nt
  v_mfma_f32_16x16x32_bf16 v[20:23], v[80:83], v[12:15], v[20:23]
  v_mfma_f32_16x16x32_bf16 v[24:27], v[84:87], v[12:15], v[24:27]
  s_waitcnt vmcnt(6)
  s_cbranch_vccnz L235_x
  s_waitcnt vmcnt(4)
L235_x:
  buffer_load_dwordx4 v[168:171], v40, s[8:11], s36 offen offset:256 nt
  s_memrealtime s[0:1]
  v_mov_b32_dpp v6, v30 row_newbcast:2 row_mask:0xf bank_mask:0x3
  v_mov_b32_dpp v37, v30 row_newbcast:10 row_mask:0xf bank_mask:0xc
  v_or_b32 v5, v6, v37
  v_and_b32 v8, v5, v42
  v_and_b32 v9, v5, v43
  v_and_b32 v10, v5, v44
  v_and_b32 v11, v5, v45
  s_nop 1
  v_mfma_f32_16x16x32_bf16 v[16:19], v[88:91], v[8:11], v[16:19]
  v_mfma_f32_16x16x32_bf16 v[20:23], v[92:95], v[8:11], v[20:23]
  s_waitcnt vmcnt(6)
  s_cbranch_vccnz L236_x
  s_waitcnt vmcnt(4)
L236_x:
  buffer_load_dwordx4 v[172:175], v40, s[8:11], s37 offen offset:0 nt
  s_waitcnt lgkmcnt(0)
  s_lshl4_add_u32 s44, s0, s101
  s_sub_u32 s44, s44, s100
  s_add_u32 s100, s100, s87
  s_cmp_gt_i32 s44, 0
  s_cselect_b64 vcc, -1, 0
  s_cmp_lg_u32 s92, 0
  s_cbranch_scc1 L237_nopub
  v_mov_b32 v59, s0
  s_mov_b64 exec, 1
  buffer_store_dword v59, v58, s[4:7], 0 offen sc1
  s_mov_b64 exec, -1
  v_add_u32 v58, 2048, v58
L237_nopub:
  v_mfma_f32_16x16x32_bf16 v[24:27], v[96:99], v[8:11], v[24:27]
  v_mov_b32_dpp v6, v30 row_newbcast:3 row_mask:0xf bank_mask:0x3
  v_mov_b32_dpp v37, v30 row_newbcast:11 row_mask:0xf bank_mask:0xc
  v_or_b32 v5, v6, v37
  v_and_b32 v12, v5, v42
  v_and_b32 v13, v5, v43
  v_and_b32 v14, v5, v44
  v_and_b32 v15, v5, v45
  s_nop 1
  v_mfma_f32_16x16x32_bf16 v[16:19], v[100:103], v[12:15], v[16:19]
  s_waitcnt vmcnt(6)
  s_cbranch_vccnz L238_x
  s_waitcnt vmcnt(4)
L238_x:
  buffer_load_dwordx4 v[176:179], v40, s[8:11], s37 offen offset:128 nt
  v_mfma_f32_16x16x32_bf16 v[20:23], v[104:107], v[12:15], v[20:23]
  v_mfma_f32_16x16x32_bf16 v[24:27], v[108:111], v[12:15], v[24:27]
  s_waitcnt vmcnt(6)
  s_cbranch_vccnz L239_x
  s_waitcnt vmcnt(4)
L239_x:
  buffer_load_dwordx4 v[180:183], v40, s[8:11], s37 offen offset:256 nt
  v_mov_b32_dpp v6, v30 row_newbcast:4 row_mask:0xf bank_mask:0x3
  v_mov_b32_dpp v37, v30 row_newbcast:12 row_mask:0xf bank_mask:0xc
  v_or_b32 v5, v6, v37
  v_and_b32 v8, v5, v42
  v_and_b32 v9, v5, v43
  v_and_b32 v10, v5, v44
  v_and_b32 v11, v5, v45
  s_nop 1
  v_mfma_f32_16x16x32_bf16 v[16:19], v[112:115], v[8:11], v[16:19]
  v_mfma_f32_16x16x32_bf16 v[20:23], v[116:119], v[8:11], v[20:23]
  s_waitcnt vmcnt(6)
  s_cbranch_vccnz L240_x
  s_waitcnt vmcnt(4)
L240_x:
  buffer_load_dwordx4 v[184:187], v40, s[8:11], s38 offen offset:0 nt
  s_memrealtime s[0:1]
  v_mfma_f32_16x16x32_bf16 v[24:27], v[120:123], v[8:11], v[24:27]
  v_mov_b32_dpp v6, v30 row_newbcast:5 row_mask:0xf bank_mask:0x3
  v_mov_b32_dpp v37, v30 row_newbcast:13 row_mask:0xf bank_mask:0xc
  v_or_b32 v5, v6, v37
  v_and_b32 v12, v5, v42
  v_and_b32 v13, v5, v43
  v_and_b32 v14, v5, v44
  v_and_b32 v15, v5, v45
  s_nop 1
  v_mfma_f32_16x16x32_bf16 v[16:19], v[124:127], v[12:15], v[16:19]
  s_waitcnt vmcnt(6)
  s_cbranch_vccnz L241_x
  s_waitcnt vmcnt(4)
L241_x:
  buffer_load_dwordx4 v[188:191], v40, s[8:11], s38 offen offset:128 nt
  s_waitcnt lgkmcnt(0)
  s_lshl4_add_u32 s44, s0, s101
  s_sub_u32 s44, s44, s100
  s_add_u32 s100, s100, s87
  s_cmp_gt_i32 s44, 0
  s_cselect_b64 vcc, -1, 0
  v_mfma_f32_16x16x32_bf16 v[20:23], v[128:131], v[12:15], v[20:23]
  v_mfma_f32_16x16x32_bf16 v[24:27], v[132:135], v[12:15], v[24:27]
  s_waitcnt vmcnt(6)
  s_cbranch_vccnz L242_x
  s_waitcnt vmcnt(4)
L242_x:
  buffer_load_dwordx4 v[192:195], v40, s[8:11], s38 offen offset:256 nt
  v_mov_b32_dpp v6, v30 row_newbcast:6 row_mask:0xf bank_mask:0x3
  v_mov_b32_dpp v37, v30 row_newbcast:14 row_mask:0xf bank_mask:0xc
  v_or_b32 v5, v6, v37
  v_and_b32 v8, v5, v42
  v_and_b32 v9, v5, v43
  v_and_b32 v10, v5, v44
  v_and_b32 v11, v5, v45
  s_nop 1
  v_mfma_f32_16x16x32_bf16 v[16:19], v[136:139], v[8:11], v[16:19]
  v_mfma_f32_16x16x32_bf16 v[20:23], v[140:143], v[8:11], v[20:23]
  s_waitcnt vmcnt(6)
  s_cbranch_vccnz L243_x
  s_waitcnt vmcnt(4)
L243_x:
  buffer_load_dwordx4 v[196:199], v40, s[8:11], s39 offen offset:0 nt
  v_mfma_f32_16x16x32_bf16 v[24:27], v[144:147], v[8:11], v[24:27]
  v_mov_b32_dpp v6, v30 row_newbcast:7 row_mask:0xf bank_mask:0x3
  v_mov_b32_dpp v37, v30 row_newbcast:15 row_mask:0xf bank_mask:0xc
  v_or_b32 v5, v6, v37
  v_and_b32 v12, v5, v42
  v_and_b32 v13, v5, v43
  v_and_b32 v14, v5, v44
  v_and_b32 v15, v5, v45
  s_nop 1
  v_mfma_f32_16x16x32_bf16 v[16:19], v[148:151], v[12:15], v[16:19]
  s_waitcnt vmcnt(6)
  s_cbranch_vccnz L244_x
  s_waitcnt vmcnt(4)
L244_x:
  buffer_load_dwordx4 v[200:203], v40, s[8:11], s39 offen offset:128 nt
  s_memrealtime s[0:1]
  v_mfma_f32_16x16x32_bf16 v[20:23], v[152:155], v[12:15], v[20:23]
  v_mfma_f32_16x16x32_bf16 v[24:27], v[156:159], v[12:15], v[24:27]
  s_waitcnt vmcnt(6)
  s_cbranch_vccnz L245_x
  s_waitcnt vmcnt(4)
L245_x:
  buffer_load_dwordx4 v[204:207], v40, s[8:11], s39 offen offset:256 nt
  s_waitcnt lgkmcnt(0)
  s_lshl4_add_u32 s44, s0, s101
  s_sub_u32 s44, s44, s100
  s_add_u32 s100, s100, s87
  s_cmp_gt_i32 s44, 0
  s_cselect_b64 vcc, -1, 0
  s_mov_b64 exec, s[94:95]
  ds_write_b128 v62, v[16:19] offset:0
  ds_write_b128 v62, v[20:23] offset:256
  ds_write_b128 v62, v[24:27] offset:512
  s_mov_b64 exec, 1
  ds_add_u32 v63, v60 offset:36
  s_mov_b64 exec, -1
  v_add_u32 v62, 1536, v62
  v_lshlrev_b32 v60, 4, v60
  v_mov_b32_dpp v6, v31 row_newbcast:0 row_mask:0xf bank_mask:0x3
  v_mov_b32_dpp v37, v31 row_newbcast:8 row_mask:0xf bank_mask:0xc
  v_or_b32 v5, v6, v37
  v_and_b32 v8, v5, v42
  v_and_b32 v9, v5, v43
  v_and_b32 v10, v5, v44
  v_and_b32 v11, v5, v45
  s_nop 1
  v_mfma_f32_16x16x32_bf16 v[16:19], v[160:163], v[8:11], 0
  v_mfma_f32_16x16x32_bf16 v[20:23], v[164:167], v[8:11], 0
  s_waitcnt vmcnt(6)
  s_cbranch_vccnz L246_x
  s_waitcnt vmcnt(4)
L246_x:
  buffer_load_dwordx4 v[208:211], v40, s[8:11], s40 offen offset:0 nt
  v_mfma_f32_16x16x32_bf16 v[24:27], v[168:171], v[8:11], 0
  v_mov_b32_dpp v6, v31 row_newbcast:1 row_mask:0xf bank_mask:0x3
  v_mov_b32_dpp v37, v31 row_newbcast:9 row_mask:0xf bank_mask:0xc
  v_or_b32 v5, v6, v37
  v_and_b32 v12, v5, v42
  v_and_b32 v13, v5, v43
  v_and_b32 v14, v5, v44
  v_and_b32 v15, v5, v45
  s_nop 1
  v_mfma_f32_16x16x32_bf16 v[16:19], v[172:175], v[12:15], v[16:19]
  s_waitcnt vmcnt(6)
  s_cbranch_vccnz L247_x
  s_waitcnt vmcnt(4)
L247_x:
  buffer_load_dwordx4 v[212:215], v40, s[8:11], s40 offen offset:128 nt
  v_mfma_f32_16x16x32_bf16 v[20:23], v[176:179], v[12:15], v[20:23]
  v_mfma_f32_16x16x32_bf16 v[24:27], v[180:183], v[12:15], v[24:27]
  s_waitcnt vmcnt(6)
  s_cbranch_vccnz L248_x
  s_waitcnt vmcnt(4)
L248_x:
  buffer_load_dwordx4 v[216:219], v40, s[8:11], s40 offen offset:256 nt
  s_memrealtime s[0:1]
  v_mov_b32_dpp v6, v31 row_newbcast:2 row_mask:0xf bank_mask:0x3
  v_mov_b32_dpp v37, v31 row_newbcast:10 row_mask:0xf bank_mask:0xc
  v_or_b32 v5, v6, v37
  v_and_b32 v8, v5, v42
  v_and_b32 v9, v5, v43
  v_and_b32 v10, v5, v44
  v_and_b32 v11, v5, v45
  s_nop 1
  v_mfma_f32_16x16x32_bf16 v[16:19], v[184:187], v[8:11], v[16:19]
  v_mfma_f32_16x16x32_bf16 v[20:23], v[188:191], v[8:11], v[20:23]
  s_waitcnt vmcnt(6)
  s_cbranch_vccnz L249_x
  s_waitcnt vmcnt(4)
L249_x:
  buffer_load_dwordx4 v[220:223], v40, s[8:11], s41 offen offset:0 nt
  s_waitcnt lgkmcnt(0)
  s_lshl4_add_u32 s44, s0, s101
  s_sub_u32 s44, s44, s100
  s_add_u32 s100, s100, s87
  s_cmp_gt_i32 s44, 0
  s_cselect_b64 vcc, -1, 0
  s_load_dword s70, s[64:65], 0
  s_load_dword s71, s[64:65], 128
  s_load_dword s72, s[64:65], 256
  s_load_dword s73, s[64:65], 384
  s_load_dword s74, s[64:65], 512
  s_load_dword s75, s[64:65], 640
  s_load_dword s76, s[64:65], 768
  s_load_dword s77, s[64:65], 896
  s_load_dword s78, s[64:65], 1024
  s_load_dword s79, s[64:65], 1152
  s_load_dword s80, s[64:65], 1280
  s_load_dword s81, s[64:65], 1408
  s_load_dword s82, s[64:65], 1536
  s_load_dword s83, s[64:65], 1664
  s_load_dword s84, s[64:65], 1792
  s_load_dword s85, s[64:65], 1920
  v_mfma_f32_16x16x32_bf16 v[24:27], v[192:195], v[8:11], v[24:27]
  s_waitcnt vmcnt(6)
  s_cbranch_vccnz L250_x
  s_waitcnt vmcnt(4)
L250_x:
  buffer_load_dwordx4 v[224:227], v40, s[8:11], s41 offen offset:128 nt
  v_mov_b32_dpp v6, v31 row_newbcast:3 row_mask:0xf bank_mask:0x3
  v_mov_b32_dpp v37, v31 row_newbcast:11 row_mask:0xf bank_mask:0xc
  v_or_b32 v5, v6, v37
  v_and_b32 v12, v5, v42
  v_and_b32 v13, v5, v43
  v_and_b32 v14, v5, v44
  v_and_b32 v15, v5, v45
  s_nop 1
  v_mfma_f32_16x16x32_bf16 v[16:19], v[196:199], v[12:15], v[16:19]
  s_waitcnt vmcnt(6)
  s_cbranch_vccnz L251_x
  s_waitcnt vmcnt(4)
L251_x:
  buffer_load_dwordx4 v[228:231], v40, s[8:11], s41 offen offset:256 nt
  v_mfma_f32_16x16x32_bf16 v[20:23], v[200:203], v[12:15], v[20:23]
  s_waitcnt vmcnt(6)
  s_cbranch_vccnz L252_x
  s_waitcnt vmcnt(4)
L252_x:
  buffer_load_dwordx4 v[232:235], v40, s[8:11], s42 offen offset:0 nt
  s_memrealtime s[0:1]
  v_mfma_f32_16x16x32_bf16 v[24:27], v[204:207], v[12:15], v[24:27]
  s_waitcnt vmcnt(6)
  s_cbranch_vccnz L253_x
  s_waitcnt vmcnt(4)
L253_x:
  buffer_load_dwordx4 v[236:239], v40, s[8:11], s42 offen offset:128 nt
  s_waitcnt lgkmcnt(0)
  s_lshl4_add_u32 s44, s0, s101
  s_sub_u32 s44, s44, s100
  s_add_u32 s100, s100, s87
  s_cmp_gt_i32 s44, 0
  s_cselect_b64 vcc, -1, 0
  s_add_u32 s64, s64, 2048
  s_addc_u32 s65, s65, 0
  s_mov_b32 s45, 0
  s_sub_u32 s47, s44, s101
  s_max_i32 s47, s47, 0
  s_lshr_b32 s47, s47, 4
  s_add_u32 s47, s47, 90
  s_sub_u32 s47, s0, s47
  s_cmp_eq_u32 s70, -1
  s_cselect_b32 s70, s47, s70
  s_add_u32 s45, s45, s70
  s_cmp_eq_u32 s71, -1
  s_cselect_b32 s71, s47, s71
  s_add_u32 s45, s45, s71
  s_cmp_eq_u32 s72, -1
  s_cselect_b32 s72, s47, s72
  s_add_u32 s45, s45, s72
  s_cmp_eq_u32 s73, -1
  s_cselect_b32 s73, s47, s73
  s_add_u32 s45, s45, s73
  s_cmp_eq_u32 s74, -1
  s_cselect_b32 s74, s47, s74
  s_add_u32 s45, s45, s74
  s_cmp_eq_u32 s75, -1
  s_cselect_b32 s75, s47, s75
  s_add_u32 s45, s45, s75
  s_cmp_eq_u32 s76, -1
  s_cselect_b32 s76, s47, s76
  s_add_u32 s45, s45, s76
  s_cmp_eq_u32 s77, -1
  s_cselect_b32 s77, s47, s77
  s_add_u32 s45, s45, s77
  s_cmp_eq_u32 s78, -1
  s_cselect_b32 s78, s47, s78
  s_add_u32 s45, s45, s78
  s_cmp_eq_u32 s79, -1
  s_cselect_b32 s79, s47, s79
  s_add_u32 s45, s45, s79
  s_cmp_eq_u32 s80, -1
  s_cselect_b32 s80, s47, s80
  s_add_u32 s45, s45, s80
  s_cmp_eq_u32 s81, -1
  s_cselect_b32 s81, s47, s81
  s_add_u32 s45, s45, s81
  s_cmp_eq_u32 s82, -1
  s_cselect_b32 s82, s47, s82
  s_add_u32 s45, s45, s82
  s_cmp_eq_u32 s83, -1
  s_cselect_b32 s83, s47, s83
  s_add_u32 s45, s45, s83
  s_cmp_eq_u32 s84, -1
  s_cselect_b32 s84, s47, s84
  s_add_u32 s45, s45, s84
  s_cmp_eq_u32 s85, -1
  s_cselect_b32 s85, s47, s85
  s_add_u32 s45, s45, s85
  s_sub_u32 s44, s45, s86
  s_mov_b32 s86, s45
  s_mul_i32 s1, s87, 6
  s_sub_u32 s44, s44, s1
  s_min_i32 s44, s44, 640
  s_max_i32 s44, s44, -640
  s_mul_hi_i32 s44, s44, 357913941
  s_add_u32 s44, s44, s87
  s_sub_u32 s98, s98, 1
  s_cselect_b32 s87, s44, s87
  s_cselect_b32 s98, 0, s98
  s_mul_i32 s44, s87, 5
  s_add_u32 s100, s45, s44
  v_mov_b32_dpp v6, v31 row_newbcast:4 row_mask:0xf bank_mask:0x3
  v_mov_b32_dpp v37, v31 row_newbcast:12 row_mask:0xf bank_mask:0xc
  v_or_b32 v5, v6, v37
  v_and_b32 v8, v5, v42
  v_and_b32 v9, v5, v43
  v_and_b32 v10, v5, v44
  v_and_b32 v11, v5, v45
  s_nop 1
  v_mfma_f32_16x16x32_bf16 v[16:19], v[208:211], v[8:11], v[16:19]
  s_waitcnt vmcnt(6)
  s_cbranch_vccnz L254_x
  s_waitcnt vmcnt(4)
L254_x:
  buffer_load_dwordx4 v[240:243], v40, s[8:11], s42 offen offset:256 nt
  v_mfma_f32_16x16x32_bf16 v[20:23], v[212:215], v[8:11], v[20:23]
  s_waitcnt vmcnt(6)
  s_cbranch_vccnz L255_x
  s_waitcnt vmcnt(4)
L255_x:
  buffer_load_dwordx4 v[244:247], v41, s[8:11], s43 offen offset:0 nt
  v_mfma_f32_16x16x32_bf16 v[24:27], v[216:219], v[8:11], v[24:27]
  s_waitcnt vmcnt(6)
  s_cbranch_vccnz L256_x
  s_waitcnt vmcnt(4)
L256_x:
  buffer_load_dwordx4 v[248:251], v41, s[8:11], s43 offen offset:128 nt
  s_memrealtime s[0:1]
  v_mov_b32_dpp v6, v31 row_newbcast:5 row_mask:0xf bank_mask:0x3
  v_mov_b32_dpp v37, v31 row_newbcast:13 row_mask:0xf bank_mask:0xc
  v_or_b32 v5, v6, v37
  v_and_b32 v12, v5, v42
  v_and_b32 v13, v5, v43
  v_and_b32 v14, v5, v44
  v_and_b32 v15, v5, v45
  s_nop 1
  v_mfma_f32_16x16x32_bf16 v[16:19], v[220:223], v[12:15], v[16:19]
  s_waitcnt vmcnt(6)
  s_cbranch_vccnz L257_x
  s_waitcnt vmcnt(4)
L257_x:
  buffer_load_dwordx4 v[252:255], v41, s[8:11], s43 offen offset:256 nt
  s_and_b32 s46, s97, 7
  s_lshr_b32 s97, s97, 4
  s_mul_i32 s46, s46, 25165824
  s_add_u32 s8, s14, s46
  s_addc_u32 s9, s15, 0
  s_waitcnt lgkmcnt(0)
  s_lshl4_add_u32 s44, s0, s101
  s_sub_u32 s44, s44, s100
  s_add_u32 s100, s100, s87
  s_cmp_gt_i32 s44, 0
  s_cselect_b64 vcc, -1, 0
  s_mov_b32 s99, 0
L_vloop:
  v_mov_b32 v28, v30
  v_mov_b32 v29, v31
  v_mov_b32 v30, v32
  v_mov_b32 v31, v33
  v_mov_b32 v32, v34
  v_mov_b32 v33, v35
  v_mfma_f32_16x16x32_bf16 v[20:23], v[224:227], v[12:15], v[20:23]
  s_waitcnt vmcnt(6)
  s_cbranch_vccnz L258_x
  s_waitcnt vmcnt(4)
L258_x:
  buffer_load_dwordx4 v[64:67], v40, s[8:11], s36 offen offset:0 nt
  v_mfma_f32_16x16x32_bf16 v[24:27], v[228:231], v[12:15], v[24:27]
  s_waitcnt vmcnt(6)
  s_cbranch_vccnz L259_x
  s_waitcnt vmcnt(4)
L259_x:
  buffer_load_dwordx4 v[68:71], v40, s[8:11], s36 offen offset:128 nt
  v_mov_b32_dpp v6, v29 row_newbcast:6 row_mask:0xf bank_mask:0x3
  v_mov_b32_dpp v37, v29 row_newbcast:14 row_mask:0xf bank_mask:0xc
  v_or_b32 v5, v6, v37
  v_and_b32 v8, v5, v42
  v_and_b32 v9, v5, v43
  v_and_b32 v10, v5, v44
  v_and_b32 v11, v5, v45
  s_nop 1
  v_mfma_f32_16x16x32_bf16 v[16:19], v[232:235], v[8:11], v[16:19]
  s_waitcnt vmcnt(6)
  s_cbranch_vccnz L260_x
  s_waitcnt vmcnt(4)
L260_x:
  buffer_load_dwordx4 v[72:75], v40, s[8:11], s36 offen offset:256 nt
  s_memrealtime s[0:1]
  v_mfma_f32_16x16x32_bf16 v[20:23], v[236:239], v[8:11], v[20:23]
  s_waitcnt vmcnt(6)
  s_cbranch_vccnz L261_x
  s_waitcnt vmcnt(4)
L261_x:
  buffer_load_dwordx4 v[76:79], v40, s[8:11], s37 offen offset:0 nt
  s_waitcnt lgkmcnt(0)
  s_lshl4_add_u32 s44, s0, s101
  s_sub_u32 s44, s44, s100
  s_add_u32 s100, s100, s87
  s_cmp_gt_i32 s44, 0
  s_cselect_b64 vcc, -1, 0
  s_cmp_lg_u32 s92, 0
  s_cbranch_scc1 L262_nopub
  v_mov_b32 v59, s0
  s_mov_b64 exec, 1
  buffer_store_dword v59, v58, s[4:7], 0 offen sc1
  s_mov_b64 exec, -1
  v_add_u32 v58, 2048, v58
L262_nopub:
  v_mfma_f32_16x16x32_bf16 v[24:27], v[240:243], v[8:11], v[24:27]
  s_waitcnt vmcnt(6)
  s_cbranch_vccnz L263_x
  s_waitcnt vmcnt(4)
L263_x:
  buffer_load_dwordx4 v[80:83], v40, s[8:11], s37 offen offset:128 nt
  v_mov_b32_dpp v6, v29 row_newbcast:7 row_mask:0xf bank_mask:0x3
  v_mov_b32_dpp v37, v29 row_newbcast:15 row_mask:0xf bank_mask:0xc
  v_or_b32 v5, v6, v37
  v_and_b32 v12, v5, v42
  v_and_b32 v13, v5, v43
  v_and_b32 v14, v5, v44
  v_and_b32 v15, v5, v45
  s_nop 1
  v_mfma_f32_16x16x32_bf16 v[16:19], v[244:247], v[12:15], v[16:19]
  s_waitcnt vmcnt(6)
  s_cbranch_vccnz L264_x
  s_waitcnt vmcnt(4)
L264_x:
  buffer_load_dwordx4 v[84:87], v40, s[8:11], s37 offen offset:256 nt
  v_mfma_f32_16x16x32_bf16 v[20:23], v[248:251], v[12:15], v[20:23]
  s_waitcnt vmcnt(6)
  s_cbranch_vccnz L265_x
  s_waitcnt vmcnt(4)
L265_x:
  buffer_load_dwordx4 v[88:91], v40, s[8:11], s38 offen offset:0 nt
  s_memrealtime s[0:1]
  v_mfma_f32_16x16x32_bf16 v[24:27], v[252:255], v[12:15], v[24:27]
  s_waitcnt vmcnt(6)
  s_cbranch_vccnz L266_x
  s_waitcnt vmcnt(4)
L266_x:
  buffer_load_dwordx4 v[92:95], v40, s[8:11], s38 offen offset:128 nt
  s_waitcnt lgkmcnt(0)
  s_lshl4_add_u32 s44, s0, s101
  s_sub_u32 s44, s44, s100
  s_add_u32 s100, s100, s87
  s_cmp_gt_i32 s44, 0
  s_cselect_b64 vcc, -1, 0
  s_mov_b64 exec, s[94:95]
  ds_write_b128 v62, v[16:19] offset:0
  ds_write_b128 v62, v[20:23] offset:256
  ds_write_b128 v62, v[24:27] offset:512
  s_mov_b64 exec, 1
  ds_add_u32 v63, v60 offset:36
  s_mov_b64 exec, -1
  v_add_u32 v62, 1536, v62
  v_lshlrev_b32 v60, 4, v60
  v_mov_b32_dpp v6, v30 row_newbcast:0 row_mask:0xf bank_mask:0x3
  v_mov_b32_dpp v37, v30 row_newbcast:8 row_mask:0xf bank_mask:0xc
  v_or_b32 v5, v6, v37
  v_and_b32 v8, v5, v42
  v_and_b32 v9, v5, v43
  v_and_b32 v10, v5, v44
  v_and_b32 v11, v5, v45
  s_nop 1
  v_mfma_f32_16x16x32_bf16 v[16:19], v[64:67], v[8:11], 0
  s_waitcnt vmcnt(6)
  s_cbranch_vccnz L267_x
  s_waitcnt vmcnt(4)
L267_x:
  buffer_load_dwordx4 v[96:99], v40, s[8:11], s38 offen offset:256 nt
  v_mfma_f32_16x16x32_bf16 v[20:23], v[68:71], v[8:11], 0
  s_waitcnt vmcnt(6)
  s_cbranch_vccnz L268_x
  s_waitcnt vmcnt(4)
L268_x:
  buffer_load_dwordx4 v[100:103], v40, s[8:11], s39 offen offset:0 nt
  v_mfma_f32_16x16x32_bf16 v[24:27], v[72:75], v[8:11], 0
  s_waitcnt vmcnt(6)
  s_cbranch_vccnz L269_x
  s_waitcnt vmcnt(4)
L269_x:
  buffer_load_dwordx4 v[104:107], v40, s[8:11], s39 offen offset:128 nt
  s_memrealtime s[0:1]
  v_mov_b32_dpp v6, v30 row_newbcast:1 row_mask:0xf bank_mask:0x3
  v_mov_b32_dpp v37, v30 row_newbcast:9 row_mask:0xf bank_mask:0xc
  v_or_b32 v5, v6, v37
  v_and_b32 v12, v5, v42
  v_and_b32 v13, v5, v43
  v_and_b32 v14, v5, v44
  v_and_b32 v15, v5, v45
  s_nop 1
  v_mfma_f32_16x16x32_bf16 v[16:19], v[76:79], v[12:15], v[16:19]
  s_waitcnt vmcnt(6)
  s_cbranch_vccnz L270_x
  s_waitcnt vmcnt(4)
L270_x:
  buffer_load_dwordx4 v[108:111], v40, s[8:11], s39 offen offset:256 nt
  s_waitcnt lgkmcnt(0)
  s_lshl4_add_u32 s44, s0, s101
  s_sub_u32 s44, s44, s100
  s_add_u32 s100, s100, s87
  s_cmp_gt_i32 s44, 0
  s_cselect_b64 vcc, -1, 0
  v_mfma_f32_16x16x32_bf16 v[20:23], v[80:83], v[12:15], v[20:23]
  s_waitcnt vmcnt(6)
  s_cbranch_vccnz L271_x
  s_waitcnt vmcnt(4)
L271_x:
  buffer_load_dwordx4 v[112:115], v40, s[8:11], s40 offen offset:0 nt
  v_mfma_f32_16x16x32_bf16 v[24:27], v[84:87], v[12:15], v[24:27]
  s_waitcnt vmcnt(6)
  s_cbranch_vccnz L272_x
  s_waitcnt vmcnt(4)
L272_x:
  buffer_load_dwordx4 v[116:119], v40, s[8:11], s40 offen offset:128 nt
  v_mov_b32_dpp v6, v30 row_newbcast:2 row_mask:0xf bank_mask:0x3
  v_mov_b32_dpp v37, v30 row_newbcast:10 row_mask:0xf bank_mask:0xc
  v_or_b32 v5, v6, v37
  v_and_b32 v8, v5, v42
  v_and_b32 v9, v5, v43
  v_and_b32 v10, v5, v44
  v_and_b32 v11, v5, v45
  s_nop 1
  v_mfma_f32_16x16x32_bf16 v[16:19], v[88:91], v[8:11], v[16:19]
  s_waitcnt vmcnt(6)
  s_cbranch_vccnz L273_x
  s_waitcnt vmcnt(4)
L273_x:
  buffer_load_dwordx4 v[120:123], v40, s[8:11], s40 offen offset:256 nt
  s_memrealtime s[0:1]
  v_mfma_f32_16x16x32_bf16 v[20:23], v[92:95], v[8:11], v[20:23]
  s_waitcnt vmcnt(6)
  s_cbranch_vccnz L274_x
  s_waitcnt vmcnt(4)
L274_x:
  buffer_load_dwordx4 v[124:127], v40, s[8:11], s41 offen offset:0 nt
  s_waitcnt lgkmcnt(0)
  s_lshl4_add_u32 s44, s0, s101
  s_sub_u32 s44, s44, s100
  s_add_u32 s100, s100, s87
  s_cmp_gt_i32 s44, 0
  s_cselect_b64 vcc, -1, 0
  s_load_dword s70, s[64:65], 0
  s_load_dword s71, s[64:65], 128
  s_load_dword s72, s[64:65], 256
  s_load_dword s73, s[64:65], 384
  s_load_dword s74, s[64:65], 512
  s_load_dword s75, s[64:65], 640
  s_load_dword s76, s[64:65], 768
  s_load_dword s77, s[64:65], 896
  s_load_dword s78, s[64:65], 1024
  s_load_dword s79, s[64:65], 1152
  s_load_dword s80, s[64:65], 1280
  s_load_dword s81, s[64:65], 1408
  s_load_dword s82, s[64:65], 1536
  s_load_dword s83, s[64:65], 1664
  s_load_dword s84, s[64:65], 1792
  s_load_dword s85, s[64:65], 1920
  v_mfma_f32_16x16x32_bf16 v[24:27], v[96:99], v[8:11], v[24:27]
  s_waitcnt vmcnt(6)
  s_cbranch_vccnz L275_x
  s_waitcnt vmcnt(4)
L275_x:
  buffer_load_dwordx4 v[128:131], v40, s[8:11], s41 offen offset:128 nt
  v_mov_b32_dpp v6, v30 row_newbcast:3 row_mask:0xf bank_mask:0x3
  v_mov_b32_dpp v37, v30 row_newbcast:11 row_mask:0xf bank_mask:0xc
  v_or_b32 v5, v6, v37
  v_and_b32 v12, v5, v42
  v_and_b32 v13, v5, v43
  v_and_b32 v14, v5, v44
  v_and_b32 v15, v5, v45
  s_nop 1
  v_mfma_f32_16x16x32_bf16 v[16:19], v[100:103], v[12:15], v[16:19]
  s_waitcnt vmcnt(6)
  s_cbranch_vccnz L276_x
  s_waitcnt vmcnt(4)
L276_x:
  buffer_load_dwordx4 v[132:135], v40, s[8:11], s41 offen offset:256 nt
  v_mfma_f32_16x16x32_bf16 v[20:23], v[104:107], v[12:15], v[20:23]
  s_waitcnt vmcnt(6)
  s_cbranch_vccnz L277_x
  s_waitcnt vmcnt(4)
L277_x:
  buffer_load_dwordx4 v[136:139], v40, s[8:11], s42 offen offset:0 nt
  s_memrealtime s[0:1]
  v_mfma_f32_16x16x32_bf16 v[24:27], v[108:111], v[12:15], v[24:27]
  s_waitcnt vmcnt(6)
  s_cbranch_vccnz L278_x
  s_waitcnt vmcnt(4)
L278_x:
  buffer_load_dwordx4 v[140:143], v40, s[8:11], s42 offen offset:128 nt
  s_waitcnt lgkmcnt(0)
  s_lshl4_add_u32 s44, s0, s101
  s_sub_u32 s44, s44, s100
  s_add_u32 s100, s100, s87
  s_cmp_gt_i32 s44, 0
  s_cselect_b64 vcc, -1, 0
  s_add_u32 s64, s64, 2048
  s_addc_u32 s65, s65, 0
  s_mov_b32 s45, 0
  s_sub_u32 s47, s44, s101
  s_max_i32 s47, s47, 0
  s_lshr_b32 s47, s47, 4
  s_add_u32 s47, s47, 90
  s_sub_u32 s47, s0, s47
  s_cmp_eq_u32 s70, -1
  s_cselect_b32 s70, s47, s70
  s_add_u32 s45, s45, s70
  s_cmp_eq_u32 s71, -1
  s_cselect_b32 s71, s47, s71
  s_add_u32 s45, s45, s71
  s_cmp_eq_u32 s72, -1
  s_cselect_b32 s72, s47, s72
  s_add_u32 s45, s45, s72
  s_cmp_eq_u32 s73, -1
  s_cselect_b32 s73, s47, s73
  s_add_u32 s45, s45, s73
  s_cmp_eq_u32 s74, -1
  s_cselect_b32 s74, s47, s74
  s_add_u32 s45, s45, s74
  s_cmp_eq_u32 s75, -1
  s_cselect_b32 s75, s47, s75
  s_add_u32 s45, s45, s75
  s_cmp_eq_u32 s76, -1
  s_cselect_b32 s76, s47, s76
  s_add_u32 s45, s45, s76
  s_cmp_eq_u32 s77, -1
  s_cselect_b32 s77, s47, s77
  s_add_u32 s45, s45, s77
  s_cmp_eq_u32 s78, -1
  s_cselect_b32 s78, s47, s78
  s_add_u32 s45, s45, s78
  s_cmp_eq_u32 s79, -1
  s_cselect_b32 s79, s47, s79
  s_add_u32 s45, s45, s79
  s_cmp_eq_u32 s80, -1
  s_cselect_b32 s80, s47, s80
  s_add_u32 s45, s45, s80
  s_cmp_eq_u32 s81, -1
  s_cselect_b32 s81, s47, s81
  s_add_u32 s45, s45, s81
  s_cmp_eq_u32 s82, -1
  s_cselect_b32 s82, s47, s82
  s_add_u32 s45, s45, s82
  s_cmp_eq_u32 s83, -1
  s_cselect_b32 s83, s47, s83
  s_add_u32 s45, s45, s83
  s_cmp_eq_u32 s84, -1
  s_cselect_b32 s84, s47, s84
  s_add_u32 s45, s45, s84
  s_cmp_eq_u32 s85, -1
  s_cselect_b32 s85, s47, s85
  s_add_u32 s45, s45, s85
  s_sub_u32 s44, s45, s86
  s_mov_b32 s86, s45
  s_mul_i32 s1, s87, 6
  s_sub_u32 s44, s44, s1
  s_min_i32 s44, s44, 640
  s_max_i32 s44, s44, -640
  s_mul_hi_i32 s44, s44, 357913941
  s_add_u32 s44, s44, s87
  s_sub_u32 s98, s98, 1
  s_cselect_b32 s87, s44, s87
  s_cselect_b32 s98, 0, s98
  s_mul_i32 s44, s87, 5
  s_add_u32 s100, s45, s44
  v_mov_b32_dpp v6, v30 row_newbcast:4 row_mask:0xf bank_mask:0x3
  v_mov_b32_dpp v37, v30 row_newbcast:12 row_mask:0xf bank_mask:0xc
  v_or_b32 v5, v6, v37
  v_and_b32 v8, v5, v42
  v_and_b32 v9, v5, v43
  v_and_b32 v10, v5, v44
  v_and_b32 v11, v5, v45
  s_nop 1
  v_mfma_f32_16x16x32_bf16 v[16:19], v[112:115], v[8:11], v[16:19]
  s_waitcnt vmcnt(6)
  s_cbranch_vccnz L279_x
  s_waitcnt vmcnt(4)
L279_x:
  buffer_load_dwordx4 v[144:147], v40, s[8:11], s42 offen offset:256 nt
  v_mfma_f32_16x16x32_bf16 v[20:23], v[116:119], v[8:11], v[20:23]
  s_waitcnt vmcnt(6)
  s_cbranch_vccnz L280_x
  s_waitcnt vmcnt(4)
L280_x:
  buffer_load_dwordx4 v[148:151], v41, s[8:11], s43 offen offset:0 nt
  v_mfma_f32_16x16x32_bf16 v[24:27], v[120:123], v[8:11], v[24:27]
  s_waitcnt vmcnt(6)
  s_cbranch_vccnz L281_x
  s_waitcnt vmcnt(4)
L281_x:
  buffer_load_dwordx4 v[152:155], v41, s[8:11], s43 offen offset:128 nt
  s_memrealtime s[0:1]
  v_mov_b32_dpp v6, v30 row_newbcast:5 row_mask:0xf bank_mask:0x3
  v_mov_b32_dpp v37, v30 row_newbcast:13 row_mask:0xf bank_mask:0xc
  v_or_b32 v5, v6, v37
  v_and_b32 v12, v5, v42
  v_and_b32 v13, v5, v43
  v_and_b32 v14, v5, v44
  v_and_b32 v15, v5, v45
  s_nop 1
  v_mfma_f32_16x16x32_bf16 v[16:19], v[124:127], v[12:15], v[16:19]
  s_waitcnt vmcnt(6)
  s_cbranch_vccnz L282_x
  s_waitcnt vmcnt(4)
L282_x:
  buffer_load_dwordx4 v[156:159], v41, s[8:11], s43 offen offset:256 nt
  s_and_b32 s46, s97, 7
  s_lshr_b32 s97, s97, 4
  s_mul_i32 s46, s46, 25165824
  s_add_u32 s8, s14, s46
  s_addc_u32 s9, s15, 0
  s_waitcnt lgkmcnt(0)
  s_lshl4_add_u32 s44, s0, s101
  s_sub_u32 s44, s44, s100
  s_add_u32 s100, s100, s87
  s_cmp_gt_i32 s44, 0
  s_cselect_b64 vcc, -1, 0
  v_mfma_f32_16x16x32_bf16 v[20:23], v[128:131], v[12:15], v[20:23]
  s_waitcnt vmcnt(6)
  s_cbranch_vccnz L283_x
  s_waitcnt vmcnt(4)
L283_x:
  buffer_load_dwordx4 v[160:163], v40, s[8:11], s36 offen offset:0 nt
  s_cmp_eq_u32 s99, 0
  s_cbranch_scc1 L_nofac
  s_lshl2_add_u32 s44, s3, 154224
  v_mov_b32 v2, s44
  s_mov_b32 s47, 2097152
L284_rdy:
  ds_read_b32 v1, v63 offset:40
  ds_read_b32 v46, v2
  s_waitcnt lgkmcnt(0)
  v_readfirstlane_b32 s96, v1
  s_nop 0
  s_cmp_lg_u32 s96, 0
  s_cbranch_scc1 L285_rdyd
  s_sub_u32 s47, s47, 1
  s_cbranch_scc0 L284_rdy
L285_rdyd:
  v_mul_f32 v61, v61, v46
  v_cvt_pk_bf16_f32 v31, v61, v61
L_nofac:
  v_mfma_f32_16x16x32_bf16 v[24:27], v[132:135], v[12:15], v[24:27]
  s_waitcnt vmcnt(6)
  s_cbranch_vccnz L286_x
  s_waitcnt vmcnt(4)
L286_x:
  buffer_load_dwordx4 v[164:167], v40, s[8:11], s36 offen offset:128 nt
  v_mov_b32_dpp v6, v30 row_newbcast:6 row_mask:0xf bank_mask:0x3
  v_mov_b32_dpp v37, v30 row_newbcast:14 row_mask:0xf bank_mask:0xc
  v_or_b32 v5, v6, v37
  v_and_b32 v8, v5, v42
  v_and_b32 v9, v5, v43
  v_and_b32 v10, v5, v44
  v_and_b32 v11, v5, v45
  s_nop 1
  v_mfma_f32_16x16x32_bf16 v[16:19], v[136:139], v[8:11], v[16:19]
  s_waitcnt vmcnt(6)
  s_cbranch_vccnz L287_x
  s_waitcnt vmcnt(4)
L287_x:
  buffer_load_dwordx4 v[168:171], v40, s[8:11], s36 offen offset:256 nt
  s_memrealtime s[0:1]
  v_mfma_f32_16x16x32_bf16 v[20:23], v[140:143], v[8:11], v[20:23]
  s_waitcnt vmcnt(6)
  s_cbranch_vccnz L288_x
  s_waitcnt vmcnt(4)
L288_x:
  buffer_load_dwordx4 v[172:175], v40, s[8:11], s37 offen offset:0 nt
  s_waitcnt lgkmcnt(0)
  s_lshl4_add_u32 s44, s0, s101
  s_sub_u32 s44, s44, s100
  s_add_u32 s100, s100, s87
  s_cmp_gt_i32 s44, 0
  s_cselect_b64 vcc, -1, 0
  s_cmp_lg_u32 s92, 0
  s_cbranch_scc1 L289_nopub
  v_mov_b32 v59, s0
  s_mov_b64 exec, 1
  buffer_store_dword v59, v58, s[4:7], 0 offen sc1
  s_mov_b64 exec, -1
  v_add_u32 v58, 2048, v58
L289_nopub:
  v_mfma_f32_16x16x32_bf16 v[24:27], v[144:147], v[8:11], v[24:27]
  s_waitcnt vmcnt(6)
  s_cbranch_vccnz L290_x
  s_waitcnt vmcnt(4)
L290_x:
  buffer_load_dwordx4 v[176:179], v40, s[8:11], s37 offen offset:128 nt
  v_mov_b32_dpp v6, v30 row_newbcast:7 row_mask:0xf bank_mask:0x3
  v_mov_b32_dpp v37, v30 row_newbcast:15 row_mask:0xf bank_mask:0xc
  v_or_b32 v5, v6, v37
  v_and_b32 v12, v5, v42
  v_and_b32 v13, v5, v43
  v_and_b32 v14, v5, v44
  v_and_b32 v15, v5, v45
  s_nop 1
  v_mfma_f32_16x16x32_bf16 v[16:19], v[148:151], v[12:15], v[16:19]
  s_waitcnt vmcnt(6)
  s_cbranch_vccnz L291_x
  s_waitcnt vmcnt(4)
L291_x:
  buffer_load_dwordx4 v[180:183], v40, s[8:11], s37 offen offset:256 nt
  v_mfma_f32_16x16x32_bf16 v[20:23], v[152:155], v[12:15], v[20:23]
  s_waitcnt vmcnt(6)
  s_cbranch_vccnz L292_x
  s_waitcnt vmcnt(4)
L292_x:
  buffer_load_dwordx4 v[184:187], v40, s[8:11], s38 offen offset:0 nt
  s_memrealtime s[0:1]
  v_mfma_f32_16x16x32_bf16 v[24:27], v[156:159], v[12:15], v[24:27]
  s_waitcnt vmcnt(6)
  s_cbranch_vccnz L293_x
  s_waitcnt vmcnt(4)
L293_x:
  buffer_load_dwordx4 v[188:191], v40, s[8:11], s38 offen offset:128 nt
  s_waitcnt lgkmcnt(0)
  s_lshl4_add_u32 s44, s0, s101
  s_sub_u32 s44, s44, s100
  s_add_u32 s100, s100, s87
  s_cmp_gt_i32 s44, 0
  s_cselect_b64 vcc, -1, 0
  s_mov_b64 exec, s[94:95]
  ds_write_b128 v62, v[16:19] offset:0
  ds_write_b128 v62, v[20:23] offset:256
  ds_write_b128 v62, v[24:27] offset:512
  s_mov_b64 exec, 1
  ds_add_u32 v63, v60 offset:36
  s_mov_b64 exec, -1
  v_add_u32 v62, 1536, v62
  v_lshlrev_b32 v60, 4, v60
  v_mov_b32_dpp v6, v31 row_newbcast:0 row_mask:0xf bank_mask:0x3
  v_mov_b32_dpp v37, v31 row_newbcast:8 row_mask:0xf bank_mask:0xc
  v_or_b32 v5, v6, v37
  v_and_b32 v8, v5, v42
  v_and_b32 v9, v5, v43
  v_and_b32 v10, v5, v44
  v_and_b32 v11, v5, v45
  s_nop 1
  v_mfma_f32_16x16x32_bf16 v[16:19], v[160:163], v[8:11], 0
  s_waitcnt vmcnt(6)
  s_cbranch_vccnz L294_x
  s_waitcnt vmcnt(4)
L294_x:
  buffer_load_dwordx4 v[192:195], v40, s[8:11], s38 offen offset:256 nt
  v_mfma_f32_16x16x32_bf16 v[20:23], v[164:167], v[8:11], 0
  s_waitcnt vmcnt(6)
  s_cbranch_vccnz L295_x
  s_waitcnt vmcnt(4)
L295_x:
  buffer_load_dwordx4 v[196:199], v40, s[8:11], s39 offen offset:0 nt
  v_mfma_f32_16x16x32_bf16 v[24:27], v[168:171], v[8:11], 0
  s_waitcnt vmcnt(6)
  s_cbranch_vccnz L296_x
  s_waitcnt vmcnt(4)
L296_x:
  buffer_load_dwordx4 v[200:203], v40, s[8:11], s39 offen offset:128 nt
  s_memrealtime s[0:1]
  v_mov_b32_dpp v6, v31 row_newbcast:1 row_mask:0xf bank_mask:0x3
  v_mov_b32_dpp v37, v31 row_newbcast:9 row_mask:0xf bank_mask:0xc
  v_or_b32 v5, v6, v37
  v_and_b32 v12, v5, v42
  v_and_b32 v13, v5, v43
  v_and_b32 v14, v5, v44
  v_and_b32 v15, v5, v45
  s_nop 1
  v_mfma_f32_16x16x32_bf16 v[16:19], v[172:175], v[12:15], v[16:19]
  s_waitcnt vmcnt(6)
  s_cbranch_vccnz L297_x
  s_waitcnt vmcnt(4)
L297_x:
  buffer_load_dwordx4 v[204:207], v40, s[8:11], s39 offen offset:256 nt
  s_waitcnt lgkmcnt(0)
  s_lshl4_add_u32 s44, s0, s101
  s_sub_u32 s44, s44, s100
  s_add_u32 s100, s100, s87
  s_cmp_gt_i32 s44, 0
  s_cselect_b64 vcc, -1, 0
  v_mfma_f32_16x16x32_bf16 v[20:23], v[176:179], v[12:15], v[20:23]
  s_waitcnt vmcnt(6)
  s_cbranch_vccnz L298_x
  s_waitcnt vmcnt(4)
L298_x:
  buffer_load_dwordx4 v[208:211], v40, s[8:11], s40 offen offset:0 nt
  v_mfma_f32_16x16x32_bf16 v[24:27], v[180:183], v[12:15], v[24:27]
  s_waitcnt vmcnt(6)
  s_cbranch_vccnz L299_x
  s_waitcnt vmcnt(4)
L299_x:
  buffer_load_dwordx4 v[212:215], v40, s[8:11], s40 offen offset:128 nt
  v_mov_b32_dpp v6, v31 row_newbcast:2 row_mask:0xf bank_mask:0x3
  v_mov_b32_dpp v37, v31 row_newbcast:10 row_mask:0xf bank_mask:0xc
  v_or_b32 v5, v6, v37
  v_and_b32 v8, v5, v42
  v_and_b32 v9, v5, v43
  v_and_b32 v10, v5, v44
  v_and_b32 v11, v5, v45
  s_nop 1
  v_mfma_f32_16x16x32_bf16 v[16:19], v[184:187], v[8:11], v[16:19]
  s_waitcnt vmcnt(6)
  s_cbranch_vccnz L300_x
  s_waitcnt vmcnt(4)
L300_x:
  buffer_load_dwordx4 v[216:219], v40, s[8:11], s40 offen offset:256 nt
  s_memrealtime s[0:1]
  v_mfma_f32_16x16x32_bf16 v[20:23], v[188:191], v[8:11], v[20:23]
  s_waitcnt vmcnt(6)
  s_cbranch_vccnz L301_x
  s_waitcnt vmcnt(4)
L301_x:
  buffer_load_dwordx4 v[220:223], v40, s[8:11], s41 offen offset:0 nt
  s_waitcnt lgkmcnt(0)
  s_lshl4_add_u32 s44, s0, s101
  s_sub_u32 s44, s44, s100
  s_add_u32 s100, s100, s87
  s_cmp_gt_i32 s44, 0
  s_cselect_b64 vcc, -1, 0
  s_load_dword s70, s[64:65], 0
  s_load_dword s71, s[64:65], 128
  s_load_dword s72, s[64:65], 256
  s_load_dword s73, s[64:65], 384
  s_load_dword s74, s[64:65], 512
  s_load_dword s75, s[64:65], 640
  s_load_dword s76, s[64:65], 768
  s_load_dword s77, s[64:65], 896
  s_load_dword s78, s[64:65], 1024
  s_load_dword s79, s[64:65], 1152
  s_load_dword s80, s[64:65], 1280
  s_load_dword s81, s[64:65], 1408
  s_load_dword s82, s[64:65], 1536
  s_load_dword s83, s[64:65], 1664
  s_load_dword s84, s[64:65], 1792
  s_load_dword s85, s[64:65], 1920
  v_mfma_f32_16x16x32_bf16 v[24:27], v[192:195], v[8:11], v[24:27]
  s_waitcnt vmcnt(6)
  s_cbranch_vccnz L302_x
  s_waitcnt vmcnt(4)
L302_x:
  buffer_load_dwordx4 v[224:227], v40, s[8:11], s41 offen offset:128 nt
  v_mov_b32_dpp v6, v31 row_newbcast:3 row_mask:0xf bank_mask:0x3
  v_mov_b32_dpp v37, v31 row_newbcast:11 row_mask:0xf bank_mask:0xc
  v_or_b32 v5, v6, v37
  v_and_b32 v12, v5, v42
  v_and_b32 v13, v5, v43
  v_and_b32 v14, v5, v44
  v_and_b32 v15, v5, v45
  s_nop 1
  v_mfma_f32_16x16x32_bf16 v[16:19], v[196:199], v[12:15], v[16:19]
  s_waitcnt vmcnt(6)
  s_cbranch_vccnz L303_x
  s_waitcnt vmcnt(4)
L303_x:
  buffer_load_dwordx4 v[228:231], v40, s[8:11], s41 offen offset:256 nt
  v_mfma_f32_16x16x32_bf16 v[20:23], v[200:203], v[12:15], v[20:23]
  s_waitcnt vmcnt(6)
  s_cbranch_vccnz L304_x
  s_waitcnt vmcnt(4)
L304_x:
  buffer_load_dwordx4 v[232:235], v40, s[8:11], s42 offen offset:0 nt
  s_memrealtime s[0:1]
  v_mfma_f32_16x16x32_bf16 v[24:27], v[204:207], v[12:15], v[24:27]
  s_waitcnt vmcnt(6)
  s_cbranch_vccnz L305_x
  s_waitcnt vmcnt(4)
L305_x:
  buffer_load_dwordx4 v[236:239], v40, s[8:11], s42 offen offset:128 nt
  s_waitcnt lgkmcnt(0)
  s_lshl4_add_u32 s44, s0, s101
  s_sub_u32 s44, s44, s100
  s_add_u32 s100, s100, s87
  s_cmp_gt_i32 s44, 0
  s_cselect_b64 vcc, -1, 0
  s_add_u32 s64, s64, 2048
  s_addc_u32 s65, s65, 0
  s_mov_b32 s45, 0
  s_sub_u32 s47, s44, s101
  s_max_i32 s47, s47, 0
  s_lshr_b32 s47, s47, 4
  s_add_u32 s47, s47, 90
  s_sub_u32 s47, s0, s47
  s_cmp_eq_u32 s70, -1
  s_cselect_b32 s70, s47, s70
  s_add_u32 s45, s45, s70
  s_cmp_eq_u32 s71, -1
  s_cselect_b32 s71, s47, s71
  s_add_u32 s45, s45, s71
  s_cmp_eq_u32 s72, -1
  s_cselect_b32 s72, s47, s72
  s_add_u32 s45, s45, s72
  s_cmp_eq_u32 s73, -1
  s_cselect_b32 s73, s47, s73
  s_add_u32 s45, s45, s73
  s_cmp_eq_u32 s74, -1
  s_cselect_b32 s74, s47, s74
  s_add_u32 s45, s45, s74
  s_cmp_eq_u32 s75, -1
  s_cselect_b32 s75, s47, s75
  s_add_u32 s45, s45, s75
  s_cmp_eq_u32 s76, -1
  s_cselect_b32 s76, s47, s76
  s_add_u32 s45, s45, s76
  s_cmp_eq_u32 s77, -1
  s_cselect_b32 s77, s47, s77
  s_add_u32 s45, s45, s77
  s_cmp_eq_u32 s78, -1
  s_cselect_b32 s78, s47, s78
  s_add_u32 s45, s45, s78
  s_cmp_eq_u32 s79, -1
  s_cselect_b32 s79, s47, s79
  s_add_u32 s45, s45, s79
  s_cmp_eq_u32 s80, -1
  s_cselect_b32 s80, s47, s80
  s_add_u32 s45, s45, s80
  s_cmp_eq_u32 s81, -1
  s_cselect_b32 s81, s47, s81
  s_add_u32 s45, s45, s81
  s_cmp_eq_u32 s82, -1
  s_cselect_b32 s82, s47, s82
  s_add_u32 s45, s45, s82
  s_cmp_eq_u32 s83, -1
  s_cselect_b32 s83, s47, s83
  s_add_u32 s45, s45, s83
  s_cmp_eq_u32 s84, -1
  s_cselect_b32 s84, s47, s84
  s_add_u32 s45, s45, s84
  s_cmp_eq_u32 s85, -1
  s_cselect_b32 s85, s47, s85
  s_add_u32 s45, s45, s85
  s_sub_u32 s44, s45, s86
  s_mov_b32 s86, s45
  s_mul_i32 s1, s87, 6
  s_sub_u32 s44, s44, s1
  s_min_i32 s44, s44, 640
  s_max_i32 s44, s44, -640
  s_mul_hi_i32 s44, s44, 357913941
  s_add_u32 s44, s44, s87
  s_sub_u32 s98, s98, 1
  s_cselect_b32 s87, s44, s87
  s_cselect_b32 s98, 0, s98
  s_mul_i32 s44, s87, 5
  s_add_u32 s100, s45, s44
  v_mov_b32_dpp v6, v31 row_newbcast:4 row_mask:0xf bank_mask:0x3
  v_mov_b32_dpp v37, v31 row_newbcast:12 row_mask:0xf bank_mask:0xc
  v_or_b32 v5, v6, v37
  v_and_b32 v8, v5, v42
  v_and_b32 v9, v5, v43
  v_and_b32 v10, v5, v44
  v_and_b32 v11, v5, v45
  s_nop 1
  v_mfma_f32_16x16x32_bf16 v[16:19], v[208:211], v[8:11], v[16:19]
  s_waitcnt vmcnt(6)
  s_cbranch_vccnz L306_x
  s_waitcnt vmcnt(4)
L306_x:
  buffer_load_dwordx4 v[240:243], v40, s[8:11], s42 offen offset:256 nt
  v_mfma_f32_16x16x32_bf16 v[20:23], v[212:215], v[8:11], v[20:23]
  s_waitcnt vmcnt(6)
  s_cbranch_vccnz L307_x
  s_waitcnt vmcnt(4)
L307_x:
  buffer_load_dwordx4 v[244:247], v41, s[8:11], s43 offen offset:0 nt
  v_mfma_f32_16x16x32_bf16 v[24:27], v[216:219], v[8:11], v[24:27]
  s_waitcnt vmcnt(6)
  s_cbranch_vccnz L308_x
  s_waitcnt vmcnt(4)
L308_x:
  buffer_load_dwordx4 v[248:251], v41, s[8:11], s43 offen offset:128 nt
  s_memrealtime s[0:1]
  v_mov_b32_dpp v6, v31 row_newbcast:5 row_mask:0xf bank_mask:0x3
  v_mov_b32_dpp v37, v31 row_newbcast:13 row_mask:0xf bank_mask:0xc
  v_or_b32 v5, v6, v37
  v_and_b32 v12, v5, v42
  v_and_b32 v13, v5, v43
  v_and_b32 v14, v5, v44
  v_and_b32 v15, v5, v45
  s_nop 1
  v_mfma_f32_16x16x32_bf16 v[16:19], v[220:223], v[12:15], v[16:19]
  s_waitcnt vmcnt(6)
  s_cbranch_vccnz L309_x
  s_waitcnt vmcnt(4)
L309_x:
  buffer_load_dwordx4 v[252:255], v41, s[8:11], s43 offen offset:256 nt
  s_and_b32 s46, s97, 7
  s_lshr_b32 s97, s97, 4
  s_mul_i32 s46, s46, 25165824
  s_add_u32 s8, s14, s46
  s_addc_u32 s9, s15, 0
  s_waitcnt lgkmcnt(0)
  s_lshl4_add_u32 s44, s0, s101
  s_sub_u32 s44, s44, s100
  s_add_u32 s100, s100, s87
  s_cmp_gt_i32 s44, 0
  s_cselect_b64 vcc, -1, 0
  s_add_u32 s99, s99, 1
  s_cmp_lt_u32 s99, 2
  s_cbranch_scc1 L_vloop
  v_mov_b32 v7, 16
  s_mov_b64 exec, 1
  ds_add_u32 v63, v7 offset:28
  s_mov_b64 exec, -1
  v_mov_b32_dpp v6, v31 row_newbcast:6 row_mask:0xf bank_mask:0x3
  v_mov_b32_dpp v37, v31 row_newbcast:14 row_mask:0xf bank_mask:0xc
  v_or_b32 v5, v6, v37
  v_and_b32 v8, v5, v42
  v_and_b32 v9, v5, v43
  v_and_b32 v10, v5, v44
  v_and_b32 v11, v5, v45
  v_mfma_f32_16x16x32_bf16 v[20:23], v[224:227], v[12:15], v[20:23]
  s_waitcnt vmcnt(6)
  v_mfma_f32_16x16x32_bf16 v[24:27], v[228:231], v[12:15], v[24:27]
  s_waitcnt vmcnt(5)
  v_mfma_f32_16x16x32_bf16 v[16:19], v[232:235], v[8:11], v[16:19]
  v_mov_b32_dpp v6, v31 row_newbcast:7 row_mask:0xf bank_mask:0x3
  v_mov_b32_dpp v37, v31 row_newbcast:15 row_mask:0xf bank_mask:0xc
  v_or_b32 v5, v6, v37
  v_and_b32 v12, v5, v42
  v_and_b32 v13, v5, v43
  v_and_b32 v14, v5, v44
  v_and_b32 v15, v5, v45
  s_waitcnt vmcnt(4)
  v_mfma_f32_16x16x32_bf16 v[20:23], v[236:239], v[8:11], v[20:23]
  s_waitcnt vmcnt(3)
  v_mfma_f32_16x16x32_bf16 v[24:27], v[240:243], v[8:11], v[24:27]
  s_waitcnt vmcnt(2)
  v_mfma_f32_16x16x32_bf16 v[16:19], v[244:247], v[12:15], v[16:19]
  s_waitcnt vmcnt(1)
  v_mfma_f32_16x16x32_bf16 v[20:23], v[248:251], v[12:15], v[20:23]
  s_waitcnt vmcnt(0)
  v_mfma_f32_16x16x32_bf16 v[24:27], v[252:255], v[12:15], v[24:27]
  s_mov_b64 exec, s[94:95]
  s_nop 2
  ds_write_b128 v62, v[16:19] offset:0
  s_nop 0
  ds_write_b128 v62, v[20:23] offset:256
  s_nop 0
  ds_write_b128 v62, v[24:27] offset:512
  s_mov_b64 exec, 1
  ds_add_rtn_u32 v1, v63, v55
  s_mov_b32 exec_lo, -1
  s_mov_b32 exec_hi, 0xffff
  ds_read_b128 v[64:67], v56 offset:0
  ds_read_b128 v[68:71], v56 offset:768
  ds_read_b128 v[72:75], v56 offset:12288
  ds_read_b128 v[76:79], v56 offset:13056
  ds_read_b128 v[80:83], v56 offset:24576
  ds_read_b128 v[84:87], v56 offset:25344
  ds_read_b128 v[88:91], v56 offset:36864
  ds_read_b128 v[92:95], v56 offset:37632
  s_waitcnt lgkmcnt(8)
  v_readfirstlane_b32 s44, v1
  s_waitcnt lgkmcnt(6)
  v_pk_add_f32 v[64:65], v[64:65], v[68:69]
  v_pk_add_f32 v[66:67], v[66:67], v[70:71]
  s_cmp_lg_u32 s44, 3
  s_cbranch_scc1 L_end
  s_waitcnt lgkmcnt(4)
  v_pk_add_f32 v[72:73], v[72:73], v[76:77]
  v_pk_add_f32 v[74:75], v[74:75], v[78:79]
  v_pk_add_f32 v[64:65], v[64:65], v[72:73]
  v_pk_add_f32 v[66:67], v[66:67], v[74:75]
  s_waitcnt lgkmcnt(2)
  v_pk_add_f32 v[80:81], v[80:81], v[84:85]
  v_pk_add_f32 v[82:83], v[82:83], v[86:87]
  v_pk_add_f32 v[64:65], v[64:65], v[80:81]
  v_pk_add_f32 v[66:67], v[66:67], v[82:83]
  s_waitcnt lgkmcnt(0)
  v_pk_add_f32 v[88:89], v[88:89], v[92:93]
  v_pk_add_f32 v[90:91], v[90:91], v[94:95]
  v_pk_add_f32 v[64:65], v[64:65], v[88:89]
  v_pk_add_f32 v[66:67], v[66:67], v[90:91]
  v_cvt_pk_bf16_f32 v2, v64, v65
  v_cvt_pk_bf16_f32 v3, v66, v67
  v_min_u32 v2, -2, v2
  v_min_u32 v3, -2, v3
  s_cmp_lg_u32 s96, 2
  s_cbranch_scc1 L310_thru
  buffer_store_dwordx2 v[2:3], v57, s[4:7], 0 offen
  s_branch L311_stored
L310_thru:
  buffer_store_dwordx2 v[2:3], v57, s[4:7], 0 offen sc1
L311_stored:
  v_mov_b32 v7, 64
  s_mov_b64 exec, 1
  ds_add_u32 v63, v7 offset:28
  s_mov_b64 exec, -1
L_end:
  s_endpgm
.p2align 8
.type L_tab,@object
L_tab:
.long 0x80000004,0xa0000064,0x800000c4,0x80000124,0x80000184,0x800001e4,0x80000244,0x800002a4
.long 0x80000014,0xa0000074,0x800000d4,0x80000134,0x80000194,0x800001f4,0x80000254,0x800002b4
.long 0x80000024,0x80000084,0x800000e4,0x80000144,0x800001a4,0x80000204,0xa0000264,0x800002c4
.long 0x80000034,0x80000094,0x800000f4,0x80000154,0x800001b4,0x80000214,0xa0000274,0x800002d4
.long 0x80000044,0x800000a4,0x80000104,0xa0000164,0x800001c4,0x80000224,0x80000284,0x800002e4
.long 0x80000054,0x800000b4,0x80000114,0xa0000174,0x800001d4,0x80000234,0x80000294,0x800002f4
.long 0x20005002,0x200450d2,0x200851a2,0x200c5232,0x20105302,0x201453d2,0x20185462,0x201c5532
.long 0x20015141,0x20055181,0x200951c1,0x200d5241,0x20115281,0x201552c1,0x20195341,0x201d5381
.long 0x20025151,0x20065191,0x200a51d1,0x200e5251,0x20125291,0x201652d1,0x201a5351,0x201e5391
.long 0x20035161,0x200751a1,0x200b51e1,0x200f5261,0x201352a1,0x201752e1,0x201b5361,0x201f53a1
.long 0x60003171,0x600131b1,0x202051f1,0x60033271,0x600432b1,0x202452f1,0x60063371,0x600733b1
.long 0x60083001,0x60093031,0x20215201,0x600b3091,0x600c30c1,0x20255301,0x600e3101,0x600f3121
.long 0x60103011,0x60113041,0x20225211,0x601330a1,0x601430d1,0x20265311,0x60163111,0x60173131
.long 0x60183021,0x60193051,0x20235221,0x601b30b1,0x700001c3,0x20275321,0x720001e3,0x730001f3
.long 0x74000203,0x75000213,0x60023231,0x77000233,0x78000243,0x60053331,0x40000263,0x40000273
.long 0x40000283,0x40000293,0x600a3061,0x400002b3,0x400002c3,0x600d30e1,0x400002e3,0x400002f3
.long 0x40000303,0x40000313,0x60123071,0x40000333,0x40000343,0x601530f1,0x40000363,0x40000373
.long 0x40000383,0x40000393,0x601a3081,0x400003b3,0x400003c3,0x710001d3,0x400003e3,0x400003f3
.long 0x40000403,0x40000413,0x76000223,0x40000433,0x40000443,0x79000253,0x40000463,0x40000473
.long 0x40000483,0x40000493,0x400002a3,0x400004b3,0x400004c3,0x400002d3,0x400004e3,0x400004f3
.long 0x00000012,0x000000e2,0x40000323,0x00000242,0x00000312,0x40000353,0x00000472,0x00000542
.long 0x00000022,0x000000f2,0x400003a3,0x00000252,0x00000322,0x400003d3,0x00000482,0x00000552
.long 0x20000032,0x00000102,0x40000423,0x00000262,0x20000332,0x40000453,0x00000492,0x00000562
.long 0x00000042,0x00000112,0x400004a3,0x00000272,0x00000342,0x400004d3,0x000004a2,0x00000572
.long 0x00000052,0x00000122,0x200001b2,0x00000282,0x00000352,0x000003e2,0x200004b2,0x00000582
.long 0x00000062,0x20000132,0x000001c2,0x00000292,0x00000362,0x000003f2,0x000004c2,0x00000592
.long 0x00000072,0x00000142,0x000001d2,0x000002a2,0x00000372,0x00000402,0x000004d2,0x000005a2
.long 0x00000082,0x00000152,0x000001e2,0x200002b2,0x00000382,0x00000412,0x000004e2,0x200005b2
.long 0x00000092,0x00000162,0x000001f2,0x000002c2,0x00000392,0x00000422,0x000004f2,0x000005c2
.long 0x000000a2,0x00000172,0x00000202,0x000002d2,0x000003a2,0x20000432,0x00000502,0x000005d2
.long 0x200000b2,0x00000182,0x00000212,0x000002e2,0x200003b2,0x00000442,0x00000512,0x000005e2
.long 0x000000c2,0x00000192,0x00000222,0x000002f2,0x000003c2,0x00000452,0x00000522,0x000005f2
.section .rodata,"a"
.p2align 6
.amdhsa_kernel adaLN_cond__gqa_block_cached__swiglu_ffn__decode_kernel
  .amdhsa_next_free_vgpr 256
  .amdhsa_next_free_sgpr 102
  .amdhsa_accum_offset 256
  .amdhsa_group_segment_fixed_size 0
  .amdhsa_kernarg_size 112
  .amdhsa_user_sgpr_count 2
  .amdhsa_user_sgpr_kernarg_segment_ptr 1
  .amdhsa_system_sgpr_workgroup_id_x 1
  .amdhsa_float_denorm_mode_32 3
.end_amdhsa_kernel
```
